```python
import torch

def _softmax(x, axis=-1):
    return torch.softmax(x, dim=axis)
def _gelu(x):
    return torch.nn.functional.gelu(x, approximate="tanh")
def _silu(x):
    return torch.nn.functional.silu(x)
def _sigmoid(x):
    return torch.sigmoid(x)
def _layernorm(x, axis=-1, eps=1e-5):
    m = x.mean(dim=axis, keepdim=True)
    v = x.var(dim=axis, keepdim=True, unbiased=False)
    return (x - m) / torch.sqrt(v + eps)
def _scatter_add(tgt, idx, src, axis=0):
    return tgt.clone().index_add_(axis, idx, src)
def _segment_sum(src, seg, n):
    out = torch.zeros((n,) + src.shape[1:], dtype=src.dtype)
    return out.index_add_(0, seg, src)
def _pad(x, pw):
    flat = tuple(v for pair in reversed(pw) for v in pair)
    return torch.nn.functional.pad(x, flat)

kernel_name = 'sequential_preLN__mha_block_cached__geglu_ffn__decode'

def setup_inputs():

    _w = (lambda a: (lambda t: t.to(torch.bfloat16) if t.is_floating_point() else t)(torch.as_tensor(a)))
    def _A_setup():
        B, Sq, D = 2, 1, 448
        H, Sk, Dh = 16, 16384, 256
        return {
            "x": _w((lambda *s: torch.randn(*s, dtype=torch.bfloat16) * 0.05)(B, Sq, D)),
            "k_cache": _w((lambda *s: torch.randn(*s, dtype=torch.bfloat16) * 3.2)(B, H, Sk, Dh)),
            "v_cache": _w((lambda *s: torch.randn(*s, dtype=torch.bfloat16) * 0.4)(B, H, Sk, Dh)),
            "wq": _w((lambda *s: torch.randn(*s, dtype=torch.bfloat16) * 3.2)(D, H * Dh) * (D ** -0.5)),
            "wo": _w((lambda *s: torch.randn(*s, dtype=torch.bfloat16) * 0.4)(H * Dh, D) * ((H * Dh) ** -0.5)),
        }
    _A_in = _A_setup()

    def _B_setup():
        B, S, D, F = 2, 1, 448, 1792
        return {
            "x": _w((lambda *s: torch.randn(*s, dtype=torch.bfloat16) * 0.05)(B, S, D)),
            "w_gate": _w((lambda *s: torch.randn(*s, dtype=torch.bfloat16) * 0.05)(D, F)),
            "w_up": _w((lambda *s: torch.randn(*s, dtype=torch.bfloat16) * 0.05)(D, F)),
            "w_down": _w((lambda *s: torch.randn(*s, dtype=torch.bfloat16) * 0.05)(F, D)),
        }
    _B_in = _B_setup()

    return {
        "A_x": _A_in["x"],
        "A_k_cache": _A_in["k_cache"],
        "A_v_cache": _A_in["v_cache"],
        "A_wq": _A_in["wq"],
        "A_wo": _A_in["wo"],
        "B_x": _B_in["x"],
        "B_w_gate": _B_in["w_gate"],
        "B_w_up": _B_in["w_up"],
        "B_w_down": _B_in["w_down"],
    }

def reference(A_x, A_k_cache, A_v_cache, A_wq, A_wo, B_x, B_w_gate, B_w_up, B_w_down):
    def _A_ref(x, k_cache, v_cache, wq, wo):
        B, Sq, D = x.shape
        H, Dh = 16, 256
        q = (lambda x, *d: x.permute(*d))((x @ wq).reshape(B, Sq, H, Dh), 0, 2, 1, 3)
        scores = torch.einsum("bhqd,bhkd->bhqk", q, k_cache) * (Dh ** -0.5)
        p = _softmax(scores, axis=-1)
        o = torch.einsum("bhqk,bhkd->bhqd", p, v_cache)
        return (lambda x, *d: x.permute(*d))(o, 0, 2, 1, 3).reshape(B, Sq, H * Dh) @ wo

    def _B_ref(x, w_gate, w_up, w_down):
        return (_gelu(x @ w_gate) * (x @ w_up)) @ w_down

    x = A_x
    h = x + _A_ref(_layernorm(x, axis=-1), A_k_cache, A_v_cache, A_wq, A_wo)
    h2 = h + _B_ref(_layernorm(h, axis=-1), B_w_gate, B_w_up, B_w_down)
    return h2
```

```asm
; @launch grid=(256,1,1) block=(512,1,1) lds=161792
.amdgcn_target "amdgcn-amd-amdhsa--gfx950"
.text
.globl sequential_preLN__mha_block_cached__geglu_ffn__decode_kernel
.p2align 8
.type sequential_preLN__mha_block_cached__geglu_ffn__decode_kernel,@function
sequential_preLN__mha_block_cached__geglu_ffn__decode_kernel:
    s_cmp_ge_u32 s2, 256
    s_cbranch_scc1 L_end
    s_load_dwordx16 s[16:31], s[0:1], 0
    s_load_dwordx8 s[32:39], s[0:1], 64
    v_and_b32 v1, 63, v0
    v_lshrrev_b32 v30, 6, v0
    s_lshr_b32 s4, s2, 3
    s_and_b32 s5, s2, 7
    v_readfirstlane_b32 s3, v30
    s_and_b32 s6, s4, 15
    s_lshr_b32 s7, s4, 4
    v_mov_b32 v40, -1
    v_mov_b32 v16, 0
    v_mov_b32 v20, 0
    v_mov_b32 v41, -1
    v_mov_b32 v17, 0
    v_mov_b32 v21, 0
    v_mov_b32 v42, -1
    v_mov_b32 v18, 0
    v_mov_b32 v22, 0
    v_mov_b32 v43, -1
    v_mov_b32 v19, 0
    v_mov_b32 v23, 0
    v_lshlrev_b32 v30, 4, v0
    v_lshlrev_b32 v31, 3, v0
    v_lshlrev_b32 v32, 3, v1
    v_mov_b32 v189, 0
    ds_write_b128 v30, v[40:43] offset:22528
    ds_write_b128 v30, v[40:43] offset:30720
    ds_write_b128 v30, v[40:43] offset:38912
    ds_write_b64 v32, v[40:41] offset:0
    ds_write_b64 v32, v[16:17] offset:2304
    v_lshrrev_b32 v30, 4, v1
    v_lshlrev_b32 v30, 14, v30
    v_and_b32 v31, 15, v1
    v_lshl_add_u32 v2, v31, 4, v30
    v_lshrrev_b32 v30, 3, v1
    v_lshlrev_b32 v30, 13, v30
    v_and_b32 v31, 7, v1
    v_lshl_add_u32 v27, v31, 4, v30
    s_and_b32 s60, s2, 0xcc
    s_bcnt1_i32_b32 s60, s60
    s_and_b32 s50, s2, 0x60
    s_bcnt1_i32_b32 s50, s50
    s_and_b32 s101, s5, 3
    s_lshl_b32 s101, s101, 21
    s_and_b32 s60, s60, 1
    s_lshl_b32 s60, s60, 13
    s_or_b32 s101, s101, s60
    s_and_b32 s48, s3, 3
    s_lshl_b32 s48, s48, 11
    s_lshr_b32 s60, s3, 2
    s_lshl_b32 s60, s60, 16
    s_or_b32 s48, s48, s60
    s_or_b32 s48, s48, s101
    s_and_b32 s61, s2, 1
    s_lshl1_add_u32 s61, s7, s61
    s_mul_i32 s61, s61, 917504
    s_and_b32 s62, s2, 0x7e
    s_lshl_b32 s62, s62, 6
    s_add_u32 s61, s61, s62
    s_sub_u32 s62, s3, 1
    s_lshl_b32 s63, s62, 16
    s_add_u32 s61, s61, s63
    s_lshl_b32 s62, s62, 10
    s_add_u32 s62, s62, 0x2000
    s_lshl_b32 s60, s4, 23
    s_mov_b32 m0, s62
    s_waitcnt lgkmcnt(0)
    s_load_dword s53, s[38:39], 0
    s_mov_b32 s56, s22
    s_and_b32 s57, s23, 0xffff
    s_mov_b32 s58, 0x380000
    s_mov_b32 s59, 0x20000
    s_mov_b32 s44, s16
    s_and_b32 s45, s17, 0xffff
    s_mov_b32 s46, 0x700
    s_mov_b32 s47, 0x20000
    s_add_u32 s8, s18, s60
    s_addc_u32 s9, s19, 0
    s_and_b32 s9, s9, 0xffff
    s_mov_b32 s10, 0x800000
    s_mov_b32 s11, 0x20000
    s_add_u32 s12, s20, s60
    s_addc_u32 s13, s21, 0
    s_and_b32 s13, s13, 0xffff
    s_mov_b32 s14, 0x800000
    s_mov_b32 s15, 0x20000
    s_mov_b32 s94, 0x800000
    s_mov_b32 s95, 0x20000
    s_cmp_lg_u32 s3, 0
    s_cbranch_scc1 L_st_1
    s_setprio 3
    v_lshrrev_b32 v30, 5, v1
    v_mul_u32_u24 v30, 896, v30
    v_and_b32 v31, 31, v1
    v_lshl_add_u32 v26, v31, 2, v30
    buffer_load_dword v200, v26, s[44:47], 0 offen offset:0
    buffer_load_dword v201, v26, s[44:47], 0 offen offset:128
    buffer_load_dword v202, v26, s[44:47], 0 offen offset:256
    buffer_load_dword v203, v26, s[44:47], 0 offen offset:384
    buffer_load_dword v204, v26, s[44:47], 0 offen offset:512
    buffer_load_dword v205, v26, s[44:47], 0 offen offset:640
    buffer_load_dword v206, v26, s[44:47], 0 offen offset:768
    s_branch L_st_2
L_st_1:
    buffer_load_dwordx4 v27, s[56:59], s61 offen nt lds
    s_add_u32 m0, m0, 7168
    s_add_u32 s61, s61, 0x70000
    buffer_load_dwordx4 v27, s[56:59], s61 offen nt lds
L_st_2:
    buffer_load_dwordx4 v[80:83], v2, s[8:11], s48 offen offset:0 nt
    buffer_load_dwordx4 v[84:87], v2, s[8:11], s48 offen offset:256 nt
    buffer_load_dwordx4 v[88:91], v2, s[8:11], s48 offen offset:512 nt
    buffer_load_dwordx4 v[92:95], v2, s[8:11], s48 offen offset:768 nt
    s_add_u32 s49, s48, 0x20000
    s_barrier
    s_mov_b32 s40, s38
    s_and_b32 s41, s39, 0xffff
    s_mov_b32 s42, 0x500000
    s_mov_b32 s43, 0x20000
    v_lshrrev_b32 v191, 3, v1
    v_lshlrev_b32 v191, 2, v191
    v_add_u32 v187, 0x6800, v191
    v_and_b32 v190, 4, v1
    v_lshlrev_b32 v190, 2, v190
    v_xor_b32 v190, 16, v190
    v_and_b32 v30, 1, v1
    v_lshlrev_b32 v30, 4, v30
    v_mov_b32 v31, 0xffff
    v_lshlrev_b32 v31, v30, v31
    v_bfe_u32 v30, v1, 1, 2
    v_cmp_eq_u32 vcc, 0, v30
    s_nop 1
    v_cndmask_b32 v4, 0, v31, vcc
    v_cmp_eq_u32 vcc, 1, v30
    s_nop 1
    v_cndmask_b32 v5, 0, v31, vcc
    v_cmp_eq_u32 vcc, 2, v30
    s_nop 1
    v_cndmask_b32 v6, 0, v31, vcc
    v_cmp_eq_u32 vcc, 3, v30
    s_nop 1
    v_cndmask_b32 v7, 0, v31, vcc
    v_mov_b32 v24, 0
    v_mov_b32 v25, 0x7149f2ca
    s_mov_b32 s51, 0xff7fffff
    s_mov_b32 s52, 0x3db8aa3b
    s_mov_b32 s54, 0
    s_mov_b32 s55, s4
    s_mov_b32 s61, s5
    s_cmp_lg_u32 s61, 1
    s_cbranch_scc1 L_rr_4
    s_cmp_lt_u32 s4, 28
    s_cbranch_scc0 L_rr_4
    s_mov_b32 s54, 2
    s_add_u32 s55, s4, 0
L_rr_4:
    s_cmp_lg_u32 s61, 2
    s_cbranch_scc1 L_rr_5
    s_cmp_lt_u32 s4, 28
    s_cbranch_scc0 L_rr_5
    s_mov_b32 s54, 3
    s_add_u32 s55, s4, 0
L_rr_5:
    s_cmp_lg_u32 s61, 3
    s_cbranch_scc1 L_rr_6
    s_cmp_lt_u32 s4, 28
    s_cbranch_scc0 L_rr_6
    s_mov_b32 s54, 1
    s_add_u32 s55, s4, 0
L_rr_6:
    s_cmp_lg_u32 s61, 5
    s_cbranch_scc1 L_rr_7
    s_cmp_ge_u32 s4, 4
    s_cbranch_scc0 L_rr_7
    s_mov_b32 s54, 1
    s_add_u32 s55, s4, 24
L_rr_7:
    s_cmp_eq_u32 s54, 1
    s_cselect_b32 s17, 24, 0
    s_cmp_eq_u32 s54, 2
    s_cselect_b32 s17, 0, s17
    s_cmp_eq_u32 s54, 3
    s_cselect_b32 s17, 0, s17
    s_sub_u32 s17, 64, s17
    s_lshl_b32 s65, s4, 11
    s_add_u32 s65, s65, 0x40000
    s_lshl_b32 s16, s4, 14
    s_add_u32 s16, s16, 0x200000
    s_getreg_b32 s100, hwreg(HW_REG_XCC_ID)
    s_bfe_u32 s100, s100, 0x10002
    s_mov_b32 s90, 0
    s_mov_b32 s91, 0
    s_cmp_lg_u32 s3, 0
    s_cbranch_scc1 L_helpers
    s_cmp_lg_u32 s5, 0
    s_cbranch_scc1 L_nz_8
    v_lshrrev_b32 v31, 1, v1
    v_lshlrev_b32 v31, 8, v31
    v_and_b32 v30, 1, v1
    v_lshl_add_u32 v31, v30, 4, v31
    s_mov_b64 exec, 0x355
    buffer_store_dwordx4 v[16:19], v31, s[40:43], s65 offen sc1
    s_mov_b64 exec, -1
L_nz_8:
    buffer_load_dwordx4 v[96:99], v2, s[8:11], s48 offen offset:1024 nt
    buffer_load_dwordx4 v[100:103], v2, s[8:11], s48 offen offset:1280 nt
    buffer_load_dwordx4 v[104:107], v2, s[8:11], s48 offen offset:1536 nt
    buffer_load_dwordx4 v[108:111], v2, s[8:11], s48 offen offset:1792 nt
    s_waitcnt vmcnt(8)
    v_lshlrev_b32 v208, 16, v200
    v_and_b32 v209, 0xffff0000, v200
    v_lshlrev_b32 v210, 16, v201
    v_and_b32 v211, 0xffff0000, v201
    v_lshlrev_b32 v212, 16, v202
    v_and_b32 v213, 0xffff0000, v202
    v_lshlrev_b32 v214, 16, v203
    v_and_b32 v215, 0xffff0000, v203
    v_lshlrev_b32 v216, 16, v204
    v_and_b32 v217, 0xffff0000, v204
    v_lshlrev_b32 v218, 16, v205
    v_and_b32 v219, 0xffff0000, v205
    v_lshlrev_b32 v220, 16, v206
    v_and_b32 v221, 0xffff0000, v206
    v_add_f32 v30, v208, v209
    v_add_f32 v30, v30, v210
    v_add_f32 v30, v30, v211
    v_add_f32 v30, v30, v212
    v_add_f32 v30, v30, v213
    v_add_f32 v30, v30, v214
    v_add_f32 v30, v30, v215
    v_add_f32 v30, v30, v216
    v_add_f32 v30, v30, v217
    v_add_f32 v30, v30, v218
    v_add_f32 v30, v30, v219
    v_add_f32 v30, v30, v220
    v_add_f32 v30, v30, v221
    s_nop 1
    v_add_f32_dpp v30, v30, v30 row_ror:8 row_mask:0xf bank_mask:0xf
    s_nop 1
    v_add_f32_dpp v30, v30, v30 row_ror:4 row_mask:0xf bank_mask:0xf
    s_nop 1
    v_add_f32_dpp v30, v30, v30 row_ror:2 row_mask:0xf bank_mask:0xf
    s_nop 1
    v_add_f32_dpp v30, v30, v30 row_ror:1 row_mask:0xf bank_mask:0xf
    v_mov_b32 v32, v30
    s_nop 1
    v_permlane16_swap_b32 v30, v32
    s_nop 1
    v_add_f32 v30, v30, v32
    v_mul_f32 v30, 0x3b124925, v30
    v_mov_b32 v31, 0
    v_sub_f32 v32, v208, v30
    v_fmac_f32 v31, v32, v32
    v_sub_f32 v32, v209, v30
    v_fmac_f32 v31, v32, v32
    v_sub_f32 v32, v210, v30
    v_fmac_f32 v31, v32, v32
    v_sub_f32 v32, v211, v30
    v_fmac_f32 v31, v32, v32
    v_sub_f32 v32, v212, v30
    v_fmac_f32 v31, v32, v32
    v_sub_f32 v32, v213, v30
    v_fmac_f32 v31, v32, v32
    v_sub_f32 v32, v214, v30
    v_fmac_f32 v31, v32, v32
    v_sub_f32 v32, v215, v30
    v_fmac_f32 v31, v32, v32
    v_sub_f32 v32, v216, v30
    v_fmac_f32 v31, v32, v32
    v_sub_f32 v32, v217, v30
    v_fmac_f32 v31, v32, v32
    v_sub_f32 v32, v218, v30
    v_fmac_f32 v31, v32, v32
    v_sub_f32 v32, v219, v30
    v_fmac_f32 v31, v32, v32
    v_sub_f32 v32, v220, v30
    v_fmac_f32 v31, v32, v32
    v_sub_f32 v32, v221, v30
    v_fmac_f32 v31, v32, v32
    s_nop 1
    v_add_f32_dpp v31, v31, v31 row_ror:8 row_mask:0xf bank_mask:0xf
    s_nop 1
    v_add_f32_dpp v31, v31, v31 row_ror:4 row_mask:0xf bank_mask:0xf
    s_nop 1
    v_add_f32_dpp v31, v31, v31 row_ror:2 row_mask:0xf bank_mask:0xf
    s_nop 1
    v_add_f32_dpp v31, v31, v31 row_ror:1 row_mask:0xf bank_mask:0xf
    v_mov_b32 v32, v31
    s_nop 1
    v_permlane16_swap_b32 v31, v32
    s_nop 1
    v_add_f32 v31, v31, v32
    v_mul_f32 v31, 0x3b124925, v31
    v_cvt_pk_bf16_f32 v31, v31, v31
    v_and_b32 v31, 0xffff0000, v31
    v_cvt_pk_bf16_f32 v30, v30, v30
    v_and_b32 v30, 0xffff0000, v30
    v_add_f32 v31, 0x3727c5ac, v31
    v_cvt_pk_bf16_f32 v31, v31, v31
    v_and_b32 v31, 0xffff0000, v31
    v_sqrt_f32 v31, v31
    s_nop 0
    v_cvt_pk_bf16_f32 v31, v31, v31
    v_and_b32 v31, 0xffff0000, v31
    v_rcp_f32 v31, v31
    v_sub_f32 v208, v208, v30
    v_cvt_pk_bf16_f32 v208, v208, v208
    v_and_b32 v208, 0xffff0000, v208
    v_mul_f32 v208, v208, v31
    v_sub_f32 v209, v209, v30
    v_cvt_pk_bf16_f32 v209, v209, v209
    v_and_b32 v209, 0xffff0000, v209
    v_mul_f32 v209, v209, v31
    v_sub_f32 v210, v210, v30
    v_cvt_pk_bf16_f32 v210, v210, v210
    v_and_b32 v210, 0xffff0000, v210
    v_mul_f32 v210, v210, v31
    v_sub_f32 v211, v211, v30
    v_cvt_pk_bf16_f32 v211, v211, v211
    v_and_b32 v211, 0xffff0000, v211
    v_mul_f32 v211, v211, v31
    v_sub_f32 v212, v212, v30
    v_cvt_pk_bf16_f32 v212, v212, v212
    v_and_b32 v212, 0xffff0000, v212
    v_mul_f32 v212, v212, v31
    v_sub_f32 v213, v213, v30
    v_cvt_pk_bf16_f32 v213, v213, v213
    v_and_b32 v213, 0xffff0000, v213
    v_mul_f32 v213, v213, v31
    v_sub_f32 v214, v214, v30
    v_cvt_pk_bf16_f32 v214, v214, v214
    v_and_b32 v214, 0xffff0000, v214
    v_mul_f32 v214, v214, v31
    v_sub_f32 v215, v215, v30
    v_cvt_pk_bf16_f32 v215, v215, v215
    v_and_b32 v215, 0xffff0000, v215
    v_mul_f32 v215, v215, v31
    v_sub_f32 v216, v216, v30
    v_cvt_pk_bf16_f32 v216, v216, v216
    v_and_b32 v216, 0xffff0000, v216
    v_mul_f32 v216, v216, v31
    v_sub_f32 v217, v217, v30
    v_cvt_pk_bf16_f32 v217, v217, v217
    v_and_b32 v217, 0xffff0000, v217
    v_mul_f32 v217, v217, v31
    v_sub_f32 v218, v218, v30
    v_cvt_pk_bf16_f32 v218, v218, v218
    v_and_b32 v218, 0xffff0000, v218
    v_mul_f32 v218, v218, v31
    v_sub_f32 v219, v219, v30
    v_cvt_pk_bf16_f32 v219, v219, v219
    v_and_b32 v219, 0xffff0000, v219
    v_mul_f32 v219, v219, v31
    v_sub_f32 v220, v220, v30
    v_cvt_pk_bf16_f32 v220, v220, v220
    v_and_b32 v220, 0xffff0000, v220
    v_mul_f32 v220, v220, v31
    v_sub_f32 v221, v221, v30
    v_cvt_pk_bf16_f32 v221, v221, v221
    v_and_b32 v221, 0xffff0000, v221
    v_mul_f32 v221, v221, v31
    v_cvt_pk_bf16_f32 v200, v208, v209
    ds_write_b32 v26, v200 offset:512
    v_cvt_pk_bf16_f32 v201, v210, v211
    ds_write_b32 v26, v201 offset:640
    v_cvt_pk_bf16_f32 v202, v212, v213
    ds_write_b32 v26, v202 offset:768
    v_cvt_pk_bf16_f32 v203, v214, v215
    ds_write_b32 v26, v203 offset:896
    v_cvt_pk_bf16_f32 v204, v216, v217
    ds_write_b32 v26, v204 offset:1024
    v_cvt_pk_bf16_f32 v205, v218, v219
    ds_write_b32 v26, v205 offset:1152
    v_cvt_pk_bf16_f32 v206, v220, v221
    ds_write_b32 v26, v206 offset:1280
    s_and_b32 s63, s2, 1
    s_lshl1_add_u32 s63, s7, s63
    s_mul_i32 s60, s63, 224
    v_bfe_u32 v30, v1, 2, 1
    v_mul_u32_u24 v30, 896, v30
    v_lshrrev_b32 v34, 4, v1
    v_lshl_add_u32 v30, v34, 3, v30
    v_add_u32 v30, s60, v30
    v_lshrrev_b32 v31, 2, v1
    v_lshlrev_b32 v31, 7, v31
    v_and_b32 v33, 3, v1
    v_lshl_add_u32 v31, v33, 3, v31
    s_waitcnt lgkmcnt(0)
    ds_read2_b64 v[48:51], v30 offset0:64 offset1:68
    ds_read2_b64 v[52:55], v30 offset0:72 offset1:76
    ds_read2_b64 v[56:59], v30 offset0:80 offset1:84
    ds_read_b64 v[60:61], v30 offset:704
    s_add_u32 s53, s53, 2
    s_and_b32 s68, s53, 0xfe
    s_or_b32 s69, s68, s100
    v_bfe_u32 v30, v1, 4, 1
    v_lshlrev_b32 v30, 16, v30
    v_and_b32 v33, 15, v1
    v_lshl_add_u32 v27, v33, 3, v30
    v_lshrrev_b32 v33, 5, v1
    v_lshl_add_u32 v27, v33, 7, v27
    s_lshl_b32 s60, s63, 10
    s_and_b32 s61, s2, 6
    s_lshl_b32 s61, s61, 7
    s_add_u32 s60, s60, s61
    s_lshl_b32 s61, s6, 12
    s_add_u32 s60, s60, s61
    s_add_u32 s60, s60, 0x10000
    s_mov_b32 s64, 0
L_wqw:
    ds_read_b32 v33, v189 offset:2312
    s_waitcnt lgkmcnt(0)
    v_readfirstlane_b32 s61, v33
    s_cmp_ge_u32 s61, 7
    s_cbranch_scc1 L_wqok
    s_add_u32 s64, s64, 1
    s_cmp_lt_u32 s64, 480000
    s_cbranch_scc1 L_wqw
L_wqok:
    ds_read_b64_tr_b16 v[248:249], v31 offset:20480
    ds_read_b64_tr_b16 v[250:251], v31 offset:20512
    ds_read_b64_tr_b16 v[252:253], v31 offset:20544
    ds_read_b64_tr_b16 v[254:255], v31 offset:20576
    ds_read_b64_tr_b16 v[200:201], v31 offset:8192
    ds_read_b64_tr_b16 v[202:203], v31 offset:10240
    ds_read_b64_tr_b16 v[204:205], v31 offset:8224
    ds_read_b64_tr_b16 v[206:207], v31 offset:10272
    ds_read_b64_tr_b16 v[208:209], v31 offset:8256
    ds_read_b64_tr_b16 v[210:211], v31 offset:10304
    ds_read_b64_tr_b16 v[212:213], v31 offset:8288
    ds_read_b64_tr_b16 v[214:215], v31 offset:10336
    ds_read_b64_tr_b16 v[216:217], v31 offset:12288
    ds_read_b64_tr_b16 v[218:219], v31 offset:14336
    ds_read_b64_tr_b16 v[220:221], v31 offset:12320
    ds_read_b64_tr_b16 v[222:223], v31 offset:14368
    ds_read_b64_tr_b16 v[224:225], v31 offset:12352
    ds_read_b64_tr_b16 v[226:227], v31 offset:14400
    ds_read_b64_tr_b16 v[228:229], v31 offset:12384
    ds_read_b64_tr_b16 v[230:231], v31 offset:14432
    ds_read_b64_tr_b16 v[232:233], v31 offset:16384
    ds_read_b64_tr_b16 v[234:235], v31 offset:18432
    ds_read_b64_tr_b16 v[236:237], v31 offset:16416
    ds_read_b64_tr_b16 v[238:239], v31 offset:18464
    ds_read_b64_tr_b16 v[240:241], v31 offset:16448
    ds_read_b64_tr_b16 v[242:243], v31 offset:18496
    ds_read_b64_tr_b16 v[244:245], v31 offset:16480
    ds_read_b64_tr_b16 v[246:247], v31 offset:18528
    s_waitcnt lgkmcnt(15)
    v_mfma_f32_16x16x16_bf16 v[40:43], v[60:61], v[248:249], 0
    v_mfma_f32_16x16x16_bf16 v[44:47], v[60:61], v[250:251], 0
    v_mfma_f32_16x16x16_bf16 v[176:179], v[60:61], v[252:253], 0
    v_mfma_f32_16x16x16_bf16 v[180:183], v[60:61], v[254:255], 0
    s_waitcnt lgkmcnt(15)
    v_mfma_f32_16x16x32_bf16 v[40:43], v[48:51], v[200:203], v[40:43]
    s_waitcnt lgkmcnt(15)
    v_mfma_f32_16x16x32_bf16 v[44:47], v[48:51], v[204:207], v[44:47]
    s_waitcnt lgkmcnt(15)
    v_mfma_f32_16x16x32_bf16 v[176:179], v[48:51], v[208:211], v[176:179]
    s_waitcnt lgkmcnt(15)
    v_mfma_f32_16x16x32_bf16 v[180:183], v[48:51], v[212:215], v[180:183]
    s_waitcnt lgkmcnt(14)
    v_mfma_f32_16x16x32_bf16 v[40:43], v[52:55], v[216:219], v[40:43]
    s_waitcnt lgkmcnt(12)
    v_mfma_f32_16x16x32_bf16 v[44:47], v[52:55], v[220:223], v[44:47]
    s_waitcnt lgkmcnt(10)
    v_mfma_f32_16x16x32_bf16 v[176:179], v[52:55], v[224:227], v[176:179]
    s_waitcnt lgkmcnt(8)
    v_mfma_f32_16x16x32_bf16 v[180:183], v[52:55], v[228:231], v[180:183]
    s_waitcnt lgkmcnt(6)
    v_mfma_f32_16x16x32_bf16 v[40:43], v[56:59], v[232:235], v[40:43]
    s_waitcnt lgkmcnt(4)
    v_mfma_f32_16x16x32_bf16 v[44:47], v[56:59], v[236:239], v[44:47]
    s_waitcnt lgkmcnt(2)
    v_mfma_f32_16x16x32_bf16 v[176:179], v[56:59], v[240:243], v[176:179]
    s_waitcnt lgkmcnt(0)
    v_mfma_f32_16x16x32_bf16 v[180:183], v[56:59], v[244:247], v[180:183]
    s_waitcnt vmcnt(4)
    s_mov_b32 vcc_lo, 0
    s_mov_b32 vcc_hi, -1
    s_movk_i32 s61, 0xff00
    s_nop 4
    v_cndmask_b32 v30, v40, v176, vcc
    v_add_u32 v30, 0x80, v30
    v_and_b32 v30, s61, v30
    v_or_b32 v30, s69, v30
    v_cndmask_b32 v31, v44, v180, vcc
    v_add_u32 v31, 0x80, v31
    v_and_b32 v31, s61, v31
    v_or_b32 v31, s69, v31
    buffer_store_dwordx2 v[30:31], v27, s[40:43], s60 offen sc1
    buffer_load_dwordx4 v[112:115], v2, s[8:11], s49 offen offset:0 nt
    buffer_load_dwordx4 v[116:119], v2, s[8:11], s49 offen offset:256 nt
    buffer_load_dwordx4 v[120:123], v2, s[8:11], s49 offen offset:512 nt
    buffer_load_dwordx4 v[124:127], v2, s[8:11], s49 offen offset:768 nt
    buffer_load_dwordx4 v[128:131], v2, s[8:11], s49 offen offset:1024 nt
    buffer_load_dwordx4 v[132:135], v2, s[8:11], s49 offen offset:1280 nt
    buffer_load_dwordx4 v[136:139], v2, s[8:11], s49 offen offset:1536 nt
    buffer_load_dwordx4 v[140:143], v2, s[8:11], s49 offen offset:1792 nt
    v_lshlrev_b32 v26, 4, v1
    s_lshl_b32 s60, s4, 12
    s_add_u32 s60, s60, 0x10000
    s_lshl_b32 s62, s4, 7
    s_add_u32 s62, s62, 0x9000
    s_mov_b32 s64, 0
L_qpoll:
    buffer_load_dwordx4 v[204:207], v26, s[40:43], s60 offen offset:0 sc1
    buffer_load_dwordx4 v[208:211], v26, s[40:43], s60 offen offset:1024 sc1
    buffer_load_dwordx4 v[212:215], v26, s[40:43], s60 offen offset:2048 sc1
    buffer_load_dwordx4 v[216:219], v26, s[40:43], s60 offen offset:3072 sc1
    buffer_load_dwordx2 v[220:221], off, s[40:43], s62 sc1
    s_waitcnt vmcnt(0)
    v_xor_b32 v224, s68, v204
    v_xor_b32 v225, s68, v205
    v_xor_b32 v226, s68, v206
    v_xor_b32 v227, s68, v207
    v_xor_b32 v228, s68, v208
    v_xor_b32 v229, s68, v209
    v_xor_b32 v230, s68, v210
    v_xor_b32 v231, s68, v211
    v_xor_b32 v232, s68, v212
    v_xor_b32 v233, s68, v213
    v_xor_b32 v234, s68, v214
    v_xor_b32 v235, s68, v215
    v_xor_b32 v236, s68, v216
    v_xor_b32 v237, s68, v217
    v_xor_b32 v238, s68, v218
    v_xor_b32 v239, s68, v219
    v_or_b32 v30, v224, v225
    v_or3_b32 v30, v30, v226, v227
    v_or3_b32 v30, v30, v228, v229
    v_or3_b32 v30, v30, v230, v231
    v_or3_b32 v30, v30, v232, v233
    v_or3_b32 v30, v30, v234, v235
    v_or3_b32 v30, v30, v236, v237
    v_or3_b32 v30, v30, v238, v239
    v_and_b32 v30, 0xfe, v30
    v_xor_b32 v31, s53, v221
    v_or_b32 v30, v30, v31
    v_cmp_ne_u32 vcc, 0, v30
    s_cbranch_vccz L_qok
    s_add_u32 s64, s64, 1
    s_cmp_lt_u32 s64, 30000
    s_cbranch_scc1 L_qpoll
L_qok:
    s_xor_b32 s60, s5, 4
    s_lshl_b32 s60, s60, 3
    v_readlane_b32 s62, v204, s60
    v_readlane_b32 s68, v208, s60
    v_readlane_b32 s63, v212, s60
    v_readlane_b32 s69, v216, s60
    s_bitcmp1_b32 s2, 0
    s_cselect_b32 s62, s68, s62
    s_cselect_b32 s63, s69, s63
    s_lshr_b32 s21, s101, 13
    s_xor_b32 s21, s21, s5
    s_and_b32 s21, s21, 1
    s_cmp_eq_u32 s7, 0
    s_cselect_b32 s60, s62, s63
    v_readfirstlane_b32 s91, v220
    s_and_b32 s91, s91, 1
    s_xor_b32 s60, s60, s100
    s_bitcmp0_b32 s60, 0
    s_cbranch_scc1 L_mix_9
    s_mul_i32 s21, s91, 5
    s_xor_b32 s21, s21, s100
    s_or_b32 s21, s21, 2
L_mix_9:
    s_xor_b32 s63, s21, s5
    s_and_b32 s63, s63, 1
    s_lshl_b32 s63, s63, 11
    s_lshr_b32 s60, s101, 21
    s_lshl_b32 s60, s60, 19
    s_or_b32 s63, s63, s60
    s_and_b32 s60, s21, 2
    s_lshl_b32 s60, s60, 2
    s_and_b32 s62, s21, 4
    s_lshl3_add_u32 s60, s62, s60
    v_lshlrev_b32 v197, 2, v1
    v_add_u32 v199, 32, v1
    v_lshl_or_b32 v196, v199, 22, s63
    v_and_b32 v198, 3, v199
    v_lshl_or_b32 v196, v198, 9, v196
    v_lshrrev_b32 v198, 2, v199
    v_lshl_or_b32 v196, v198, 14, v196
    ds_write_b32 v197, v196 offset:22528
    v_add_u32 v199, 96, v1
    v_lshl_or_b32 v196, v199, 22, s63
    v_and_b32 v198, 3, v199
    v_lshl_or_b32 v196, v198, 9, v196
    v_lshrrev_b32 v198, 2, v199
    v_lshl_or_b32 v196, v198, 14, v196
    v_or_b32 v198, 4, v196
    v_cmp_eq_u32 vcc, 4, v1
    s_nop 1
    v_cndmask_b32 v196, v196, v198, vcc
    s_mov_b32 exec_lo, 0xffff
    s_mov_b32 exec_hi, 0x0
    ds_write_b32 v197, v196 offset:22784
    s_mov_b64 exec, -1
    s_or_b32 s21, s21, 0x7000
    v_mov_b32 v192, 0
    v_mov_b32 v193, 80
    v_mov_b32 v194, 0
    v_mov_b32 v195, s21
    ds_write_b128 v189, v[192:195] offset:2496
    v_and_b32 v204, s61, v204
    v_and_b32 v205, s61, v205
    v_and_b32 v206, s61, v206
    v_and_b32 v207, s61, v207
    v_and_b32 v208, s61, v208
    v_and_b32 v209, s61, v209
    v_and_b32 v210, s61, v210
    v_and_b32 v211, s61, v211
    v_and_b32 v212, s61, v212
    v_and_b32 v213, s61, v213
    v_and_b32 v214, s61, v214
    v_and_b32 v215, s61, v215
    v_and_b32 v216, s61, v216
    v_and_b32 v217, s61, v217
    v_and_b32 v218, s61, v218
    v_and_b32 v219, s61, v219
    v_add_f32 v204, v204, v212
    v_add_f32 v205, v205, v213
    v_add_f32 v206, v206, v214
    v_add_f32 v207, v207, v215
    v_add_f32 v208, v208, v216
    v_add_f32 v209, v209, v217
    v_add_f32 v210, v210, v218
    v_add_f32 v211, v211, v219
    v_add_f32 v204, v204, v208
    v_add_f32 v205, v205, v209
    v_add_f32 v206, v206, v210
    v_add_f32 v207, v207, v211
    v_cvt_pk_bf16_f32 v40, v204, v206
    v_cvt_pk_bf16_f32 v41, v205, v207
    v_and_b32 v30, 56, v1
    v_add_lshl_u32 v30, v30, v1, 2
    ds_write2_b32 v30, v40, v41 offset0:0 offset1:8
    s_setprio 0
    s_branch L_prefetch
L_helpers:
    s_cmp_lg_u32 s3, 1
    s_cbranch_scc1 L_noreset_10
    s_and_b32 s60, s6, 7
    s_lshl1_add_u32 s60, s60, s7
    s_lshr_b32 s61, s6, 3
    s_lshl1_add_u32 s60, s60, s61
    s_lshl_b32 s60, s60, 13
    s_mul_i32 s61, s5, 640
    s_add_u32 s60, s60, s61
    s_add_u32 s60, s60, 0x80000
    v_lshlrev_b32 v30, 4, v1
    s_mov_b32 exec_hi, 255
    buffer_store_dwordx4 v[40:43], v30, s[40:43], s60 offen sc1
    s_cmp_lg_u32 s4, 31
    s_cbranch_scc1 L_n_11
    s_add_u32 s60, s60, 0x2000
    buffer_store_dwordx4 v[40:43], v30, s[40:43], s60 offen sc1
L_n_11:
    s_mov_b64 exec, -1
    s_lshl_b32 s60, s55, 8
    s_add_u32 s60, s60, 0xcc000
    s_movk_i32 s62, 128
    s_cmp_eq_u32 s54, 2
    s_cbranch_scc1 L_n_12
    s_cmp_lg_u32 s54, 1
    s_cbranch_scc1 L_n_13
    s_mul_i32 s63, s55, 9363
    s_lshr_b32 s63, s63, 16
    s_mul_i32 s61, s63, 7
    s_sub_u32 s61, s55, s61
    s_mul_i32 s60, s63, 896
    s_lshl_b32 s61, s61, 7
    s_add_u32 s60, s60, s61
    s_add_u32 s60, s60, 0xc4000
    s_movk_i32 s62, 16384
L_n_12:
    v_bfe_u32 v30, v1, 3, 1
    v_mul_u32_u24 v30, s62, v30
    v_and_b32 v31, 7, v1
    v_lshl_add_u32 v30, v31, 4, v30
    v_and_b32 v31, 16, v1
    v_lshl_add_u32 v30, v31, 9, v30
    s_mov_b32 exec_hi, 0
    buffer_store_dwordx4 v[40:43], v30, s[40:43], s60 offen sc1
    s_mov_b64 exec, -1
L_n_13:
L_noreset_10:
    v_cmp_eq_u32 vcc, 0, v1
    s_nop 1
    v_cndmask_b32 v31, 0, 1, vcc
    s_andn2_b32 s68, s101, 0x2000
    s_mul_i32 s69, s3, 0x2100
    s_and_b32 s69, s69, 0x2f00
    s_or_b32 s68, s68, s69
    s_and_b32 s69, s2, 4
    s_lshl_b32 s69, s69, 13
    s_or_b32 s68, s68, s69
    s_or_b32 s68, s68, 0xc0000
    s_xor_b32 s69, s68, 0x2000
    s_mov_b32 s66, 0x7e3c19d5
    s_mov_b32 s67, s66
    s_cmp_lt_u32 s3, 2
    s_cselect_b32 s50, 1, s50
    s_xor_b32 s60, s3, s5
    s_xor_b32 s60, s60, s100
    s_movk_i32 s26, 0x101
    s_waitcnt vmcnt(4)
    ds_add_u32 v189, v31 offset:2312
    s_bitcmp1_b32 s50, 0
    s_cbranch_scc1 L_noprobe_15
    s_bitcmp1_b32 s60, 0
    s_waitcnt lgkmcnt(0)
    s_load_dword s66, s[8:9], s68 glc
    s_load_dword s67, s[8:9], s69 glc
    buffer_load_dwordx4 v[96:99], v2, s[8:11], s48 offen offset:1024 nt
    buffer_load_dwordx4 v[100:103], v2, s[8:11], s48 offen offset:1280 nt
    buffer_load_dwordx4 v[104:107], v2, s[8:11], s48 offen offset:1536 nt
    buffer_load_dwordx4 v[108:111], v2, s[8:11], s48 offen offset:1792 nt
    s_waitcnt lgkmcnt(1)
    s_cselect_b32 s62, s66, s67
    s_cselect_b32 s63, s67, s66
    s_cmp_lg_u32 s62, 0x7e3c19d5
    s_addc_u32 s26, s26, 0
    s_cmp_lg_u32 s63, 0x7e3c19d5
    s_subb_u32 s26, s26, 0
    v_mov_b32 v33, s26
    s_mov_b64 exec, 1
    ds_add_rtn_u32 v33, v189, v33 offset:2304
    s_mov_b64 exec, -1
    s_waitcnt lgkmcnt(0)
    v_readfirstlane_b32 s61, v33
    s_add_u32 s60, s61, s26
    s_cmp_lt_u32 s60, 0x600
    s_cbranch_scc1 L_novote_14
    s_add_u32 s60, s60, 0xfa00
    v_mov_b32 v33, s60
    s_mov_b64 exec, 1
    global_atomic_add v33, v189, v33, s[36:37] offset:192 sc0 sc1
    s_waitcnt vmcnt(0)
    v_readfirstlane_b32 s61, v33
    s_add_u32 s61, s61, s60
    s_lshr_b32 s63, s61, 16
    s_and_b32 s61, s61, 0xffff
    s_cmp_lg_u32 s63, 128
    s_cbranch_scc1 L_nlast_17
    global_store_dword v189, v189, s[36:37] offset:192 sc1
L_nlast_17:
    s_cmp_lg_u32 s63, 32
    s_cbranch_scc1 L_novote_14
    s_mov_b64 exec, -1
    s_cmp_gt_u32 s61, 192
    s_cselect_b32 s60, 1, 0
    s_add_u32 s61, s53, 2
    v_mov_b32 v184, s60
    v_mov_b32 v185, s61
    v_lshlrev_b32 v34, 7, v1
    s_mov_b32 s60, 0x9000
    s_mov_b32 exec_hi, 0
    buffer_store_dwordx2 v[184:185], v34, s[40:43], s60 offen sc1
L_novote_14:
    s_mov_b64 exec, -1
    s_branch L_pjoin_16
L_noprobe_15:
    s_waitcnt vmcnt(2)
    buffer_load_dwordx4 v[96:99], v2, s[8:11], s48 offen offset:1024 nt
    buffer_load_dwordx4 v[100:103], v2, s[8:11], s48 offen offset:1280 nt
    s_waitcnt vmcnt(2)
    buffer_load_dwordx4 v[104:107], v2, s[8:11], s48 offen offset:1536 nt
    buffer_load_dwordx4 v[108:111], v2, s[8:11], s48 offen offset:1792 nt
L_pjoin_16:
    s_waitcnt vmcnt(2)
    buffer_load_dwordx4 v[112:115], v2, s[8:11], s49 offen offset:0 nt
    buffer_load_dwordx4 v[116:119], v2, s[8:11], s49 offen offset:256 nt
    s_waitcnt vmcnt(2)
    buffer_load_dwordx4 v[120:123], v2, s[8:11], s49 offen offset:512 nt
    buffer_load_dwordx4 v[124:127], v2, s[8:11], s49 offen offset:768 nt
    s_waitcnt vmcnt(2)
    buffer_load_dwordx4 v[128:131], v2, s[8:11], s49 offen offset:1024 nt
    buffer_load_dwordx4 v[132:135], v2, s[8:11], s49 offen offset:1280 nt
    s_waitcnt vmcnt(2)
    buffer_load_dwordx4 v[136:139], v2, s[8:11], s49 offen offset:1536 nt
    buffer_load_dwordx4 v[140:143], v2, s[8:11], s49 offen offset:1792 nt
    s_waitcnt lgkmcnt(0)
    s_add_u32 s53, s53, 2
    s_cmp_lg_u32 s54, 1
    s_cbranch_scc1 L_d_18
    s_mov_b32 s56, s24
    s_and_b32 s57, s25, 0xffff
    s_mov_b32 s58, 0x380000
    s_mov_b32 s59, 0x20000
    v_lshrrev_b32 v30, 3, v1
    v_mul_u32_u24 v30, 896, v30
    v_and_b32 v31, 7, v1
    v_lshl_add_u32 v26, v31, 4, v30
    s_mul_i32 s63, s55, 9363
    s_lshr_b32 s63, s63, 16
    s_mul_i32 s61, s63, 7
    s_sub_u32 s61, s55, s61
    s_mul_i32 s60, s63, 458752
    s_lshl_b32 s61, s61, 7
    s_add_u32 s60, s60, s61
    s_sub_u32 s61, s3, 1
    s_mul_i32 s62, s61, 7168
    s_add_u32 s60, s60, s62
    s_lshl_b32 s62, s61, 10
    s_add_u32 s62, s62, 0xb800
L_dma_20:
    s_mov_b32 m0, s62
    s_waitcnt vmcnt(3)
    buffer_load_dwordx4 v26, s[56:59], s60 offen nt lds
    s_add_u32 s60, s60, 50176
    s_add_u32 s62, s62, 7168
    s_add_u32 s61, s61, 7
    s_cmp_lt_u32 s61, 64
    s_cbranch_scc1 L_dma_20
    s_branch L_prefetch
L_d_18:
    s_cmp_lg_u32 s54, 2
    s_cbranch_scc1 L_d_19
    s_mov_b32 s56, s28
    s_and_b32 s57, s29, 0xffff
    s_mov_b32 s58, 0x188000
    s_mov_b32 s59, 0x20000
    v_lshrrev_b32 v30, 3, v1
    v_mul_u32_u24 v30, 3584, v30
    v_and_b32 v31, 7, v1
    v_lshl_add_u32 v26, v31, 4, v30
    s_lshl_b32 s60, s55, 7
    s_sub_u32 s61, s3, 1
    s_mul_i32 s62, s61, 28672
    s_add_u32 s60, s60, s62
    s_lshl_b32 s62, s61, 10
    s_add_u32 s62, s62, 0xb800
L_dma_21:
    s_mov_b32 m0, s62
    s_waitcnt vmcnt(3)
    buffer_load_dwordx4 v26, s[56:59], s60 offen nt lds
    s_add_u32 s60, s60, 200704
    s_add_u32 s62, s62, 7168
    s_add_u32 s61, s61, 7
    s_cmp_lt_u32 s61, 56
    s_cbranch_scc1 L_dma_21
    s_mov_b32 s56, s30
    s_and_b32 s57, s31, 0xffff
    s_mov_b32 s58, 0x188000
    s_mov_b32 s59, 0x20000
    v_lshrrev_b32 v30, 3, v1
    v_mul_u32_u24 v30, 3584, v30
    v_and_b32 v31, 7, v1
    v_lshl_add_u32 v26, v31, 4, v30
    s_lshl_b32 s60, s55, 7
    s_sub_u32 s61, s3, 1
    s_mul_i32 s62, s61, 28672
    s_add_u32 s60, s60, s62
    s_lshl_b32 s62, s61, 10
    s_add_u32 s62, s62, 0x19800
L_dma_22:
    s_mov_b32 m0, s62
    s_waitcnt vmcnt(3)
    buffer_load_dwordx4 v26, s[56:59], s60 offen nt lds
    s_add_u32 s60, s60, 200704
    s_add_u32 s62, s62, 7168
    s_add_u32 s61, s61, 7
    s_cmp_lt_u32 s61, 56
    s_cbranch_scc1 L_dma_22
    s_branch L_prefetch
L_d_19:
    s_cmp_lg_u32 s54, 3
    s_cbranch_scc1 L_prefetch
    s_mov_b32 s56, s32
    s_and_b32 s57, s33, 0xffff
    s_mov_b32 s58, 0x188000
    s_mov_b32 s59, 0x20000
    v_lshrrev_b32 v30, 1, v1
    v_mul_u32_u24 v30, 896, v30
    v_and_b32 v31, 1, v1
    v_lshl_add_u32 v26, v31, 4, v30
    s_lshl_b32 s60, s55, 5
    s_sub_u32 s61, s3, 1
    s_mul_i32 s62, s61, 28672
    s_add_u32 s60, s60, s62
    s_lshl_b32 s62, s61, 10
    s_add_u32 s62, s62, 0xb800
L_dma_23:
    s_mov_b32 m0, s62
    s_waitcnt vmcnt(3)
    buffer_load_dwordx4 v26, s[56:59], s60 offen nt lds
    s_add_u32 s60, s60, 200704
    s_add_u32 s62, s62, 7168
    s_add_u32 s61, s61, 7
    s_cmp_lt_u32 s61, 56
    s_cbranch_scc1 L_dma_23
L_prefetch:
    s_add_u32 s48, s48, 0x40000
    s_add_u32 s49, s49, 0x40000
    s_waitcnt vmcnt(2)
    buffer_load_dwordx4 v[144:147], v2, s[8:11], s48 offen offset:0 nt
    buffer_load_dwordx4 v[148:151], v2, s[8:11], s48 offen offset:256 nt
    s_waitcnt vmcnt(2)
    buffer_load_dwordx4 v[152:155], v2, s[8:11], s48 offen offset:512 nt
    buffer_load_dwordx4 v[156:159], v2, s[8:11], s48 offen offset:768 nt
    s_waitcnt vmcnt(2)
    buffer_load_dwordx4 v[160:163], v2, s[8:11], s48 offen offset:1024 nt
    buffer_load_dwordx4 v[164:167], v2, s[8:11], s48 offen offset:1280 nt
    s_waitcnt vmcnt(2)
    buffer_load_dwordx4 v[168:171], v2, s[8:11], s48 offen offset:1536 nt
    buffer_load_dwordx4 v[172:175], v2, s[8:11], s48 offen offset:1792 nt
    s_waitcnt vmcnt(2)
    buffer_load_dwordx4 v[204:207], v2, s[8:11], s49 offen offset:0 nt
    buffer_load_dwordx4 v[208:211], v2, s[8:11], s49 offen offset:256 nt
    s_waitcnt vmcnt(2)
    buffer_load_dwordx4 v[212:215], v2, s[8:11], s49 offen offset:512 nt
    buffer_load_dwordx4 v[216:219], v2, s[8:11], s49 offen offset:768 nt
    s_waitcnt vmcnt(2)
    buffer_load_dwordx4 v[220:223], v2, s[8:11], s49 offen offset:1024 nt
    buffer_load_dwordx4 v[224:227], v2, s[8:11], s49 offen offset:1280 nt
    s_waitcnt vmcnt(2)
    buffer_load_dwordx4 v[228:231], v2, s[8:11], s49 offen offset:1536 nt
    buffer_load_dwordx4 v[232:235], v2, s[8:11], s49 offen offset:1792 nt
    s_sub_u32 s62, s3, 1
    s_cmp_gt_u32 s62, 3
    s_cbranch_scc1 L_nopr
    s_lshr_b32 s62, s62, 1
    s_bitcmp0_b32 s3, 0
    s_cbranch_scc1 L_prv
    s_and_b32 s60, s2, 15
    s_lshl1_add_u32 s60, s60, s62
    s_lshl_b32 s60, s60, 8
    s_lshr_b32 s61, s2, 4
    s_lshl_b32 s61, s61, 14
    s_add_u32 s60, s60, s61
    s_and_b32 s61, s2, 4
    s_lshl_b32 s61, s61, 11
    s_add_u32 s61, s61, s60
    s_add_u32 s61, s61, 0x140000
    s_mov_b64 s[96:97], s[38:39]
    s_movk_i32 s26, 0x2
    s_branch L_prg
L_prv:
    s_xor_b32 s61, s100, s5
    s_and_b32 s61, s61, 1
    s_lshl_b32 s61, s61, 13
    s_andn2_b32 s60, s101, 0x2000
    s_or_b32 s61, s61, s60
    s_and_b32 s60, s2, 4
    s_lshl_b32 s60, s60, 13
    s_or_b32 s61, s61, s60
    s_or_b32 s61, s61, 0xc0000
    s_lshl_b32 s62, s62, 8
    s_or_b32 s61, s61, s62
    s_mov_b64 s[96:97], s[12:13]
    s_mov_b32 s26, 2
L_prg:
    s_xor_b32 s60, s61, 0x2000
    s_waitcnt lgkmcnt(0)
    s_mov_b32 s62, 0x7e3c19d5
    s_mov_b32 s63, s62
    s_load_dword s62, s[96:97], s60 glc
    s_load_dword s63, s[96:97], s61 glc
    s_waitcnt lgkmcnt(1)
    s_mov_b64 s[66:67], s[62:63]
    s_cmp_lg_u32 s66, 0x7e3c19d5
    s_addc_u32 s26, s26, 0
    s_cmp_lg_u32 s67, 0x7e3c19d5
    s_subb_u32 s26, s26, 0
    s_add_u32 s60, s60, 128
    s_add_u32 s61, s61, 128
    s_waitcnt lgkmcnt(0)
    s_mov_b32 s62, 0x7e3c19d5
    s_mov_b32 s63, s62
    s_load_dword s63, s[96:97], s61 glc
    s_load_dword s62, s[96:97], s60 glc
    s_waitcnt lgkmcnt(1)
    s_mov_b64 s[66:67], s[62:63]
    s_cmp_lg_u32 s66, 0x7e3c19d5
    s_addc_u32 s26, s26, 0
    s_cmp_lg_u32 s67, 0x7e3c19d5
    s_subb_u32 s26, s26, 0
    s_add_u32 s60, s60, 128
    s_add_u32 s61, s61, 128
    s_waitcnt lgkmcnt(0)
    s_bitcmp1_b32 s3, 0
    s_cselect_b32 s60, 11, 0
    s_lshl_b32 s26, s26, s60
    s_add_u32 s26, s26, 0x100000
    v_mov_b32 v31, s26
    s_mov_b64 exec, 1
    s_waitcnt vmcnt(0)
    ds_add_rtn_u32 v30, v189, v31 offset:2316
    s_waitcnt lgkmcnt(0)
    v_add_u32 v31, v31, v30
    v_cmp_le_u32 vcc, 0x400000, v31
    s_cbranch_vccz L_pre
    global_atomic_add v189, v31, s[36:37] sc1
L_pre:
    s_mov_b64 exec, -1
L_nopr:
    v_and_b32 v31, 15, v1
    v_lshlrev_b32 v31, 4, v31
    s_mov_b32 s64, 0
L_qwait:
    ds_read_b128 v[8:11], v31 offset:0
    ds_read_b128 v[12:15], v31 offset:256
    s_waitcnt lgkmcnt(0)
    v_max3_u32 v30, v8, v9, v10
    v_max3_u32 v30, v30, v11, v12
    v_max3_u32 v30, v30, v13, v14
    v_max_u32 v30, v30, v15
    v_cmp_eq_u32 vcc, -1, v30
    s_cbranch_vccz L_qgo
    s_add_u32 s64, s64, 1
    s_cmp_lt_u32 s64, 480000
    s_cbranch_scc1 L_qwait
L_qgo:
    v_mov_b32 v3, 4
    s_mov_b64 exec, 1
    ds_add_rtn_u32 v3, v189, v3 offset:2308
    s_mov_b64 exec, -1
    s_waitcnt lgkmcnt(0)
    s_mov_b64 exec, 1
    ds_read_b32 v188, v3 offset:22528
    s_mov_b64 exec, -1
    s_waitcnt lgkmcnt(0)
    v_readfirstlane_b32 s68, v188
    s_cmp_eq_u32 s68, -1
    s_cbranch_scc1 L_spin_25
L_rb_24:
    s_and_b32 s69, s68, 3
    s_and_b32 s49, s68, 0x3ffe00
    s_lshl_b32 s49, s49, 2
    s_lshr_b32 s60, s68, 17
    s_and_b32 s60, s60, 0x7fe0
    v_add_u32 v185, s60, v187
    s_cmp_eq_u32 s69, 0
    s_cselect_b32 s92, s8, s12
    s_cselect_b32 s93, s9, s13
    ds_read_b32 v184, v185
    s_waitcnt vmcnt(2)
    s_lshl_b32 s27, s3, 22
    buffer_load_dwordx4 v[48:51], v2, s[92:95], s49 offen offset:0 nt
    buffer_load_dwordx4 v[52:55], v2, s[92:95], s49 offen offset:256 nt
    v_dot2_f32_bf16 v26, v80, v8, 0
    v_dot2_f32_bf16 v28, v84, v12, 0
    v_dot2_f32_bf16 v26, v81, v9, v26
    v_dot2_f32_bf16 v28, v85, v13, v28
    v_dot2_f32_bf16 v26, v82, v10, v26
    v_dot2_f32_bf16 v28, v86, v14, v28
    v_dot2_f32_bf16 v26, v83, v11, v26
    v_dot2_f32_bf16 v28, v87, v15, v28
    v_dot2_f32_bf16 v27, v88, v8, 0
    v_dot2_f32_bf16 v29, v92, v12, 0
    v_dot2_f32_bf16 v27, v89, v9, v27
    v_dot2_f32_bf16 v29, v93, v13, v29
    v_dot2_f32_bf16 v27, v90, v10, v27
    v_dot2_f32_bf16 v29, v94, v14, v29
    v_dot2_f32_bf16 v27, v91, v11, v27
    v_dot2_f32_bf16 v29, v95, v15, v29
    v_dot2_f32_bf16 v35, v96, v8, 0
    v_dot2_f32_bf16 v38, v100, v12, 0
    v_dot2_f32_bf16 v35, v97, v9, v35
    v_dot2_f32_bf16 v38, v101, v13, v38
    v_dot2_f32_bf16 v35, v98, v10, v35
    v_dot2_f32_bf16 v38, v102, v14, v38
    v_dot2_f32_bf16 v35, v99, v11, v35
    v_dot2_f32_bf16 v38, v103, v15, v38
    v_dot2_f32_bf16 v36, v104, v8, 0
    v_dot2_f32_bf16 v39, v108, v12, 0
    v_dot2_f32_bf16 v36, v105, v9, v36
    v_dot2_f32_bf16 v39, v109, v13, v39
    v_dot2_f32_bf16 v36, v106, v10, v36
    v_dot2_f32_bf16 v39, v110, v14, v39
    v_dot2_f32_bf16 v36, v107, v11, v36
    v_dot2_f32_bf16 v39, v111, v15, v39
    v_add_f32 v26, v26, v28
    v_add_f32 v27, v27, v29
    v_add_f32 v35, v35, v38
    v_add_f32 v36, v36, v39
    v_add_f32_dpp v30, v26, v26 row_ror:8 row_mask:0xf bank_mask:0x3
    v_add_f32_dpp v31, v27, v27 row_ror:8 row_mask:0xf bank_mask:0x3
    v_add_f32_dpp v30, v35, v35 row_ror:8 row_mask:0xf bank_mask:0xc
    v_add_f32_dpp v31, v36, v36 row_ror:8 row_mask:0xf bank_mask:0xc
    s_nop 0
    v_add_f32_dpp v30, v30, v30 row_half_mirror row_mask:0xf bank_mask:0x5
    v_add_f32_dpp v30, v31, v31 row_half_mirror row_mask:0xf bank_mask:0xa
    s_nop 1
    v_add_f32_dpp v30, v30, v30 quad_perm:[1,0,3,2] row_mask:0xf bank_mask:0xf
    s_nop 1
    v_add_f32_dpp v30, v30, v30 quad_perm:[2,3,0,1] row_mask:0xf bank_mask:0xf
    s_lshr_b32 s60, s27, 17
    s_and_b32 s60, s60, 0x7fe0
    v_mov_b32_dpp v31, v30 row_shl:4 row_mask:0xf bank_mask:0xf
    v_add_u32 v33, s60, v187
    s_mov_b32 exec_lo, 0x01010101
    s_mov_b32 exec_hi, 0x01010101
    v_cvt_pk_bf16_f32 v31, v30, v31
    ds_write_b32 v33, v31
    s_mov_b64 exec, -1
    s_add_u32 s27, s27, 0x2000000
    v_dot2_f32_bf16 v26, v112, v8, 0
    v_dot2_f32_bf16 v28, v116, v12, 0
    v_dot2_f32_bf16 v26, v113, v9, v26
    v_dot2_f32_bf16 v28, v117, v13, v28
    v_dot2_f32_bf16 v26, v114, v10, v26
    v_dot2_f32_bf16 v28, v118, v14, v28
    v_dot2_f32_bf16 v26, v115, v11, v26
    v_dot2_f32_bf16 v28, v119, v15, v28
    v_dot2_f32_bf16 v27, v120, v8, 0
    v_dot2_f32_bf16 v29, v124, v12, 0
    v_dot2_f32_bf16 v27, v121, v9, v27
    v_dot2_f32_bf16 v29, v125, v13, v29
    v_dot2_f32_bf16 v27, v122, v10, v27
    v_dot2_f32_bf16 v29, v126, v14, v29
    v_dot2_f32_bf16 v27, v123, v11, v27
    v_dot2_f32_bf16 v29, v127, v15, v29
    v_dot2_f32_bf16 v35, v128, v8, 0
    v_dot2_f32_bf16 v38, v132, v12, 0
    v_dot2_f32_bf16 v35, v129, v9, v35
    v_dot2_f32_bf16 v38, v133, v13, v38
    v_dot2_f32_bf16 v35, v130, v10, v35
    v_dot2_f32_bf16 v38, v134, v14, v38
    v_dot2_f32_bf16 v35, v131, v11, v35
    v_dot2_f32_bf16 v38, v135, v15, v38
    v_dot2_f32_bf16 v36, v136, v8, 0
    v_dot2_f32_bf16 v39, v140, v12, 0
    v_dot2_f32_bf16 v36, v137, v9, v36
    v_dot2_f32_bf16 v39, v141, v13, v39
    v_dot2_f32_bf16 v36, v138, v10, v36
    v_dot2_f32_bf16 v39, v142, v14, v39
    v_dot2_f32_bf16 v36, v139, v11, v36
    v_dot2_f32_bf16 v39, v143, v15, v39
    v_add_f32 v26, v26, v28
    v_add_f32 v27, v27, v29
    v_add_f32 v35, v35, v38
    v_add_f32 v36, v36, v39
    v_add_f32_dpp v30, v26, v26 row_ror:8 row_mask:0xf bank_mask:0x3
    v_add_f32_dpp v31, v27, v27 row_ror:8 row_mask:0xf bank_mask:0x3
    v_add_f32_dpp v30, v35, v35 row_ror:8 row_mask:0xf bank_mask:0xc
    v_add_f32_dpp v31, v36, v36 row_ror:8 row_mask:0xf bank_mask:0xc
    s_nop 0
    v_add_f32_dpp v30, v30, v30 row_half_mirror row_mask:0xf bank_mask:0x5
    v_add_f32_dpp v30, v31, v31 row_half_mirror row_mask:0xf bank_mask:0xa
    s_nop 1
    v_add_f32_dpp v30, v30, v30 quad_perm:[1,0,3,2] row_mask:0xf bank_mask:0xf
    s_nop 1
    v_add_f32_dpp v30, v30, v30 quad_perm:[2,3,0,1] row_mask:0xf bank_mask:0xf
    s_lshr_b32 s60, s27, 17
    s_and_b32 s60, s60, 0x7fe0
    v_mov_b32_dpp v31, v30 row_shl:4 row_mask:0xf bank_mask:0xf
    v_add_u32 v33, s60, v187
    s_mov_b32 exec_lo, 0x01010101
    s_mov_b32 exec_hi, 0x01010101
    v_cvt_pk_bf16_f32 v31, v30, v31
    ds_write_b32 v33, v31
    s_mov_b64 exec, -1
    s_add_u32 s27, s27, 0x2000000
    v_dot2_f32_bf16 v26, v144, v8, 0
    v_dot2_f32_bf16 v28, v148, v12, 0
    v_dot2_f32_bf16 v26, v145, v9, v26
    v_dot2_f32_bf16 v28, v149, v13, v28
    v_dot2_f32_bf16 v26, v146, v10, v26
    v_dot2_f32_bf16 v28, v150, v14, v28
    v_dot2_f32_bf16 v26, v147, v11, v26
    v_dot2_f32_bf16 v28, v151, v15, v28
    v_dot2_f32_bf16 v27, v152, v8, 0
    v_dot2_f32_bf16 v29, v156, v12, 0
    v_dot2_f32_bf16 v27, v153, v9, v27
    v_dot2_f32_bf16 v29, v157, v13, v29
    v_dot2_f32_bf16 v27, v154, v10, v27
    v_dot2_f32_bf16 v29, v158, v14, v29
    v_dot2_f32_bf16 v27, v155, v11, v27
    v_dot2_f32_bf16 v29, v159, v15, v29
    v_dot2_f32_bf16 v35, v160, v8, 0
    v_dot2_f32_bf16 v38, v164, v12, 0
    v_dot2_f32_bf16 v35, v161, v9, v35
    v_dot2_f32_bf16 v38, v165, v13, v38
    v_dot2_f32_bf16 v35, v162, v10, v35
    v_dot2_f32_bf16 v38, v166, v14, v38
    v_dot2_f32_bf16 v35, v163, v11, v35
    v_dot2_f32_bf16 v38, v167, v15, v38
    v_dot2_f32_bf16 v36, v168, v8, 0
    v_dot2_f32_bf16 v39, v172, v12, 0
    v_dot2_f32_bf16 v36, v169, v9, v36
    v_dot2_f32_bf16 v39, v173, v13, v39
    v_dot2_f32_bf16 v36, v170, v10, v36
    v_dot2_f32_bf16 v39, v174, v14, v39
    v_dot2_f32_bf16 v36, v171, v11, v36
    v_dot2_f32_bf16 v39, v175, v15, v39
    v_add_f32 v26, v26, v28
    v_add_f32 v27, v27, v29
    v_add_f32 v35, v35, v38
    v_add_f32 v36, v36, v39
    v_add_f32_dpp v30, v26, v26 row_ror:8 row_mask:0xf bank_mask:0x3
    v_add_f32_dpp v31, v27, v27 row_ror:8 row_mask:0xf bank_mask:0x3
    v_add_f32_dpp v30, v35, v35 row_ror:8 row_mask:0xf bank_mask:0xc
    v_add_f32_dpp v31, v36, v36 row_ror:8 row_mask:0xf bank_mask:0xc
    s_nop 0
    v_add_f32_dpp v30, v30, v30 row_half_mirror row_mask:0xf bank_mask:0x5
    v_add_f32_dpp v30, v31, v31 row_half_mirror row_mask:0xf bank_mask:0xa
    s_nop 1
    v_add_f32_dpp v30, v30, v30 quad_perm:[1,0,3,2] row_mask:0xf bank_mask:0xf
    s_nop 1
    v_add_f32_dpp v30, v30, v30 quad_perm:[2,3,0,1] row_mask:0xf bank_mask:0xf
    s_lshr_b32 s60, s27, 17
    s_and_b32 s60, s60, 0x7fe0
    v_mov_b32_dpp v31, v30 row_shl:4 row_mask:0xf bank_mask:0xf
    v_add_u32 v33, s60, v187
    s_mov_b32 exec_lo, 0x01010101
    s_mov_b32 exec_hi, 0x01010101
    v_cvt_pk_bf16_f32 v31, v30, v31
    ds_write_b32 v33, v31
    s_mov_b64 exec, -1
    s_add_u32 s27, s27, 0x2000000
    s_waitcnt vmcnt(2)
    buffer_load_dwordx4 v[56:59], v2, s[92:95], s49 offen offset:512 nt
    buffer_load_dwordx4 v[60:63], v2, s[92:95], s49 offen offset:768 nt
    v_dot2_f32_bf16 v26, v204, v8, 0
    v_dot2_f32_bf16 v28, v208, v12, 0
    v_dot2_f32_bf16 v26, v205, v9, v26
    v_dot2_f32_bf16 v28, v209, v13, v28
    v_dot2_f32_bf16 v26, v206, v10, v26
    v_dot2_f32_bf16 v28, v210, v14, v28
    v_dot2_f32_bf16 v26, v207, v11, v26
    v_dot2_f32_bf16 v28, v211, v15, v28
    v_dot2_f32_bf16 v27, v212, v8, 0
    v_dot2_f32_bf16 v29, v216, v12, 0
    v_dot2_f32_bf16 v27, v213, v9, v27
    v_dot2_f32_bf16 v29, v217, v13, v29
    v_dot2_f32_bf16 v27, v214, v10, v27
    v_dot2_f32_bf16 v29, v218, v14, v29
    v_dot2_f32_bf16 v27, v215, v11, v27
    v_dot2_f32_bf16 v29, v219, v15, v29
    v_dot2_f32_bf16 v35, v220, v8, 0
    v_dot2_f32_bf16 v38, v224, v12, 0
    v_dot2_f32_bf16 v35, v221, v9, v35
    v_dot2_f32_bf16 v38, v225, v13, v38
    v_dot2_f32_bf16 v35, v222, v10, v35
    v_dot2_f32_bf16 v38, v226, v14, v38
    v_dot2_f32_bf16 v35, v223, v11, v35
    v_dot2_f32_bf16 v38, v227, v15, v38
    v_dot2_f32_bf16 v36, v228, v8, 0
    v_dot2_f32_bf16 v39, v232, v12, 0
    v_dot2_f32_bf16 v36, v229, v9, v36
    v_dot2_f32_bf16 v39, v233, v13, v39
    v_dot2_f32_bf16 v36, v230, v10, v36
    v_dot2_f32_bf16 v39, v234, v14, v39
    v_dot2_f32_bf16 v36, v231, v11, v36
    v_dot2_f32_bf16 v39, v235, v15, v39
    v_add_f32 v26, v26, v28
    v_add_f32 v27, v27, v29
    v_add_f32 v35, v35, v38
    v_add_f32 v36, v36, v39
    v_add_f32_dpp v30, v26, v26 row_ror:8 row_mask:0xf bank_mask:0x3
    v_add_f32_dpp v31, v27, v27 row_ror:8 row_mask:0xf bank_mask:0x3
    v_add_f32_dpp v30, v35, v35 row_ror:8 row_mask:0xf bank_mask:0xc
    v_add_f32_dpp v31, v36, v36 row_ror:8 row_mask:0xf bank_mask:0xc
    s_nop 0
    v_add_f32_dpp v30, v30, v30 row_half_mirror row_mask:0xf bank_mask:0x5
    v_add_f32_dpp v30, v31, v31 row_half_mirror row_mask:0xf bank_mask:0xa
    s_nop 1
    v_add_f32_dpp v30, v30, v30 quad_perm:[1,0,3,2] row_mask:0xf bank_mask:0xf
    s_nop 1
    v_add_f32_dpp v30, v30, v30 quad_perm:[2,3,0,1] row_mask:0xf bank_mask:0xf
    s_lshr_b32 s60, s27, 17
    s_and_b32 s60, s60, 0x7fe0
    v_mov_b32_dpp v31, v30 row_shl:4 row_mask:0xf bank_mask:0xf
    v_add_u32 v33, s60, v187
    s_mov_b32 exec_lo, 0x01010101
    s_mov_b32 exec_hi, 0x01010101
    v_cvt_pk_bf16_f32 v31, v30, v31
    ds_write_b32 v33, v31
    s_mov_b64 exec, -1
    s_add_u32 s27, s27, 0x2000000
L_next:
    s_bitcmp1_b32 s27, 3
    s_cbranch_scc1 L_pub
L_next2:
    s_bitcmp1_b32 s68, 2
    s_cbranch_scc1 L_claim
L_disp:
    s_mov_b32 s48, s49
    s_mov_b32 s27, s68
    s_cmp_lg_u32 s69, 0
    s_cbranch_scc1 L_notk
    s_waitcnt vmcnt(2)
    buffer_load_dwordx4 v[64:67], v2, s[8:11], s48 offen offset:1024 nt
    buffer_load_dwordx4 v[68:71], v2, s[8:11], s48 offen offset:1280 nt
    v_dot2_f32_bf16 v26, v48, v8, 0
    v_dot2_f32_bf16 v28, v52, v12, 0
    v_dot2_f32_bf16 v26, v49, v9, v26
    v_dot2_f32_bf16 v28, v53, v13, v28
    v_dot2_f32_bf16 v26, v50, v10, v26
    v_dot2_f32_bf16 v28, v54, v14, v28
    v_dot2_f32_bf16 v26, v51, v11, v26
    v_dot2_f32_bf16 v28, v55, v15, v28
    s_waitcnt vmcnt(2)
    buffer_load_dwordx4 v[72:75], v2, s[8:11], s48 offen offset:1536 nt
    buffer_load_dwordx4 v[76:79], v2, s[8:11], s48 offen offset:1792 nt
    v_mov_b32 v3, 4
    s_mov_b64 exec, 1
    ds_add_rtn_u32 v3, v189, v3 offset:2308
    s_mov_b64 exec, -1
    v_dot2_f32_bf16 v27, v56, v8, 0
    v_dot2_f32_bf16 v29, v60, v12, 0
    v_dot2_f32_bf16 v27, v57, v9, v27
    v_dot2_f32_bf16 v29, v61, v13, v29
    v_dot2_f32_bf16 v27, v58, v10, v27
    v_dot2_f32_bf16 v29, v62, v14, v29
    v_dot2_f32_bf16 v27, v59, v11, v27
    v_dot2_f32_bf16 v29, v63, v15, v29
    s_waitcnt lgkmcnt(0)
    s_mov_b64 exec, 1
    ds_read_b32 v188, v3 offset:22528
    s_mov_b64 exec, -1
    s_waitcnt lgkmcnt(0)
    v_readfirstlane_b32 s68, v188
    s_cmp_eq_u32 s68, -1
    s_cbranch_scc1 L_spin_28
L_rb_27:
    s_and_b32 s69, s68, 3
    s_and_b32 s49, s68, 0x3ffe00
    s_lshl_b32 s49, s49, 2
    s_lshr_b32 s60, s68, 17
    s_and_b32 s60, s60, 0x7fe0
    v_add_u32 v185, s60, v187
    s_cmp_eq_u32 s69, 0
    s_cselect_b32 s92, s8, s12
    s_cselect_b32 s93, s9, s13
    ds_read_b32 v184, v185
    s_waitcnt vmcnt(2)
    buffer_load_dwordx4 v[48:51], v2, s[92:95], s49 offen offset:0 nt
    buffer_load_dwordx4 v[52:55], v2, s[92:95], s49 offen offset:256 nt
    v_dot2_f32_bf16 v35, v64, v8, 0
    v_dot2_f32_bf16 v38, v68, v12, 0
    v_dot2_f32_bf16 v35, v65, v9, v35
    v_dot2_f32_bf16 v38, v69, v13, v38
    v_dot2_f32_bf16 v35, v66, v10, v35
    v_dot2_f32_bf16 v38, v70, v14, v38
    v_dot2_f32_bf16 v35, v67, v11, v35
    v_dot2_f32_bf16 v38, v71, v15, v38
    s_waitcnt vmcnt(2)
    buffer_load_dwordx4 v[56:59], v2, s[92:95], s49 offen offset:512 nt
    buffer_load_dwordx4 v[60:63], v2, s[92:95], s49 offen offset:768 nt
    v_dot2_f32_bf16 v36, v72, v8, 0
    v_dot2_f32_bf16 v39, v76, v12, 0
    v_dot2_f32_bf16 v36, v73, v9, v36
    v_dot2_f32_bf16 v39, v77, v13, v39
    v_dot2_f32_bf16 v36, v74, v10, v36
    v_dot2_f32_bf16 v39, v78, v14, v39
    v_dot2_f32_bf16 v36, v75, v11, v36
    v_dot2_f32_bf16 v39, v79, v15, v39
    v_add_f32 v26, v26, v28
    v_add_f32 v27, v27, v29
    v_add_f32 v35, v35, v38
    v_add_f32 v36, v36, v39
    v_add_f32_dpp v30, v26, v26 row_ror:8 row_mask:0xf bank_mask:0x3
    v_add_f32_dpp v31, v27, v27 row_ror:8 row_mask:0xf bank_mask:0x3
    v_add_f32_dpp v30, v35, v35 row_ror:8 row_mask:0xf bank_mask:0xc
    v_add_f32_dpp v31, v36, v36 row_ror:8 row_mask:0xf bank_mask:0xc
    s_nop 0
    v_add_f32_dpp v30, v30, v30 row_half_mirror row_mask:0xf bank_mask:0x5
    v_add_f32_dpp v30, v31, v31 row_half_mirror row_mask:0xf bank_mask:0xa
    s_nop 1
    v_add_f32_dpp v30, v30, v30 quad_perm:[1,0,3,2] row_mask:0xf bank_mask:0xf
    s_nop 1
    v_add_f32_dpp v30, v30, v30 quad_perm:[2,3,0,1] row_mask:0xf bank_mask:0xf
    s_lshr_b32 s60, s27, 17
    s_and_b32 s60, s60, 0x7fe0
    v_mov_b32_dpp v31, v30 row_shl:4 row_mask:0xf bank_mask:0xf
    v_add_u32 v33, s60, v187
    s_mov_b32 exec_lo, 0x01010101
    s_mov_b32 exec_hi, 0x01010101
    v_cvt_pk_bf16_f32 v31, v30, v31
    ds_write_b32 v33, v31
    s_mov_b64 exec, -1
    s_bitset0_b32 s68, 4
    s_branch L_next
L_pub:
    v_lshlrev_b32 v192, 4, v1
    s_mov_b32 s64, 0
    s_bitcmp0_b32 s27, 6
    s_cbranch_scc1 L_pubp_30
    s_bitcmp1_b32 s27, 7
    s_cbranch_scc1 L_pubk_40
    s_mov_b32 s64, 0
L_tl_41:
    global_load_dword v193, v189, s[36:37] sc1
L_tc_42:
    s_waitcnt vmcnt(0)
    v_readfirstlane_b32 s60, v193
    s_cmp_ge_u32 s60, 0x40000000
    s_cbranch_scc1 L_td_43
    s_add_u32 s64, s64, 1
    s_cmp_lt_u32 s64, 30000
    s_cbranch_scc1 L_tl_41
L_td_43:
    s_and_b32 s60, s60, 0x7ff
    s_cmp_gt_u32 s60, 1024
    s_cselect_b32 s60, 32, 0
    s_xor_b32 s60, s60, s27
    s_bitcmp0_b32 s60, 5
    s_cbranch_scc1 L_pubx_37
L_pubk_40:
    s_mov_b32 s64, 0
    v_mov_b32 v212, 0
    v_mov_b32 v213, 0
    v_mov_b32 v214, 0
    v_mov_b32 v215, 0
L_publ_31:
    ds_read_b128 v[204:207], v192 offset:27648
    ds_read_b128 v[208:211], v192 offset:28672
    s_mov_b32 exec_lo, 0xffffffff
    s_mov_b32 exec_hi, 0x0
    ds_read_b128 v[212:215], v192 offset:29696
    s_mov_b64 exec, -1
    s_waitcnt lgkmcnt(0)
    v_max_u32 v193, v204, v205
    v_max3_u32 v193, v193, v206, v207
    v_max3_u32 v193, v193, v208, v209
    v_max3_u32 v193, v193, v210, v211
    v_max3_u32 v193, v193, v212, v213
    v_max3_u32 v193, v193, v214, v215
    v_cmp_eq_u32 vcc, -1, v193
    s_cbranch_vccz L_pubo_32
    s_add_u32 s64, s64, 1
    s_cmp_lt_u32 s64, 240000
    s_cbranch_scc1 L_publ_31
L_pubo_32:
    s_mov_b32 s60, s2
    s_lshr_b32 s61, s60, 0
    s_lshl_b32 s61, s61, 12
    s_and_b32 s60, s60, 0
    s_lshl_b32 s60, s60, 8
    s_add_u32 s60, s60, s61
    s_add_u32 s60, s60, 0x280000
    v_lshrrev_b32 v193, 4, v1
    v_lshlrev_b32 v193, 8, v193
    v_and_b32 v192, 15, v1
    v_lshl_add_u32 v192, v192, 4, v193
    buffer_store_dwordx4 v[204:207], v192, s[40:43], s60 offen sc1 nt
    s_add_u32 s60, s60, 0x400
    buffer_store_dwordx4 v[208:211], v192, s[40:43], s60 offen sc1 nt
    s_add_u32 s60, s60, 0x400
    s_mov_b32 exec_lo, 0xffffffff
    s_mov_b32 exec_hi, 0x0
    buffer_store_dwordx4 v[212:215], v192, s[40:43], s60 offen sc1 nt
    s_add_u32 s60, s60, 0x400
    s_lshl_b32 s61, s2, 7
    s_add_u32 s61, s61, 0x50000
    v_mov_b32 v193, s53
    s_mov_b64 exec, 1
    s_waitcnt vmcnt(0)
    buffer_store_dword v193, off, s[40:43], s61 sc1
    s_branch L_pubx_37
L_pubp_30:
    ds_read_b64 v[204:205], v189 offset:2320
    v_lshrrev_b32 v194, 4, v1
    v_lshlrev_b32 v194, 2, v194
    v_and_b32 v195, 0xf0, v192
    v_lshrrev_b32 v197, 1, v1
    ds_read_b32 v239, v194 offset:2328
    ds_read_b32 v240, v194 offset:2344
    ds_read_b32 v241, v194 offset:2360
    ds_read_b32 v242, v194 offset:2376
    ds_read_b32 v243, v194 offset:2392
    s_waitcnt lgkmcnt(0)
    v_readfirstlane_b32 s60, v204
    v_readfirstlane_b32 s61, v205
L_publ_33:
    ds_read_b128 v[204:207], v192 offset:26624
    ds_read_b128 v[208:211], v192 offset:27648
    ds_read_b128 v[212:215], v192 offset:28672
    ds_read_b128 v[216:219], v192 offset:29696
    ds_read_b128 v[220:223], v192 offset:30720
    ds_read_b128 v[224:227], v192 offset:31744
    ds_read_b128 v[228:231], v192 offset:32768
    ds_read_b128 v[232:235], v192 offset:33792
    s_lshl_b32 s62, s60, 1
    s_waitcnt lgkmcnt(7)
    v_max3_u32 v193, v204, v205, v206
    v_max_u32 v193, v193, v207
    v_cmp_eq_u32 vcc, -1, v193
    s_bcnt1_i32_b64 s63, vcc
    s_add_u32 s62, s62, s63
    s_waitcnt lgkmcnt(6)
    v_max3_u32 v193, v208, v209, v210
    v_max_u32 v193, v193, v211
    v_cmp_eq_u32 vcc, -1, v193
    s_bcnt1_i32_b64 s63, vcc
    s_add_u32 s62, s62, s63
    s_waitcnt lgkmcnt(5)
    v_max3_u32 v193, v212, v213, v214
    v_max_u32 v193, v193, v215
    v_cmp_eq_u32 vcc, -1, v193
    s_bcnt1_i32_b64 s63, vcc
    s_add_u32 s62, s62, s63
    s_waitcnt lgkmcnt(4)
    v_max3_u32 v193, v216, v217, v218
    v_max_u32 v193, v193, v219
    v_cmp_eq_u32 vcc, -1, v193
    s_bcnt1_i32_b64 s63, vcc
    s_add_u32 s62, s62, s63
    s_waitcnt lgkmcnt(3)
    v_max3_u32 v193, v220, v221, v222
    v_max_u32 v193, v193, v223
    v_cmp_eq_u32 vcc, -1, v193
    s_bcnt1_i32_b64 s63, vcc
    s_add_u32 s62, s62, s63
    s_waitcnt lgkmcnt(2)
    v_max3_u32 v193, v224, v225, v226
    v_max_u32 v193, v193, v227
    v_cmp_eq_u32 vcc, -1, v193
    s_bcnt1_i32_b64 s63, vcc
    s_add_u32 s62, s62, s63
    s_waitcnt lgkmcnt(1)
    v_max3_u32 v193, v228, v229, v230
    v_max_u32 v193, v193, v231
    v_cmp_eq_u32 vcc, -1, v193
    s_bcnt1_i32_b64 s63, vcc
    s_add_u32 s62, s62, s63
    s_waitcnt lgkmcnt(0)
    v_max3_u32 v193, v232, v233, v234
    v_max_u32 v193, v193, v235
    v_cmp_eq_u32 vcc, -1, v193
    s_bcnt1_i32_b64 s63, vcc
    s_add_u32 s62, s62, s63
    s_cmp_eq_u32 s62, 512
    s_cbranch_scc1 L_pubo_35
    s_add_u32 s64, s64, 1
    s_cmp_lt_u32 s64, 120000
    s_cbranch_scc1 L_publ_33
L_pubo_35:
    s_sub_u32 s60, s60, 112
    v_lshl_add_u32 v239, v239, 5, v195
    v_add_u32 v193, -16, v197
    v_cmp_gt_u32 vcc, s60, v193
    s_mov_b64 exec, vcc
    buffer_store_dwordx4 v[216:219], v239, s[40:43], s61 offen sc1 nt
    s_mov_b64 exec, -1
    v_lshl_add_u32 v240, v240, 5, v195
    v_add_u32 v193, 16, v197
    v_cmp_gt_u32 vcc, s60, v193
    s_mov_b64 exec, vcc
    buffer_store_dwordx4 v[220:223], v240, s[40:43], s61 offen sc1 nt
    s_mov_b64 exec, -1
    v_lshl_add_u32 v241, v241, 5, v195
    v_add_u32 v193, 48, v197
    v_cmp_gt_u32 vcc, s60, v193
    s_mov_b64 exec, vcc
    buffer_store_dwordx4 v[224:227], v241, s[40:43], s61 offen sc1 nt
    s_mov_b64 exec, -1
    v_lshl_add_u32 v242, v242, 5, v195
    v_add_u32 v193, 80, v197
    v_cmp_gt_u32 vcc, s60, v193
    s_mov_b64 exec, vcc
    buffer_store_dwordx4 v[228:231], v242, s[40:43], s61 offen sc1 nt
    s_mov_b64 exec, -1
    v_lshl_add_u32 v243, v243, 5, v195
    v_add_u32 v193, 112, v197
    v_cmp_gt_u32 vcc, s60, v193
    s_mov_b64 exec, vcc
    buffer_store_dwordx4 v[232:235], v243, s[40:43], s61 offen sc1 nt
    s_mov_b64 exec, -1
    v_mov_b32 v196, 0xff7fffff
    v_max3_f32 v196, v196, v204, v205
    v_lshlrev_b32 v193, 16, v204
    v_lshlrev_b32 v195, 16, v205
    v_max3_f32 v196, v196, v193, v195
    v_max3_f32 v196, v196, v206, v207
    v_lshlrev_b32 v193, 16, v206
    v_lshlrev_b32 v195, 16, v207
    v_max3_f32 v196, v196, v193, v195
    v_max3_f32 v196, v196, v208, v209
    v_lshlrev_b32 v193, 16, v208
    v_lshlrev_b32 v195, 16, v209
    v_max3_f32 v196, v196, v193, v195
    v_max3_f32 v196, v196, v210, v211
    v_lshlrev_b32 v193, 16, v210
    v_lshlrev_b32 v195, 16, v211
    v_max3_f32 v196, v196, v193, v195
    v_max3_f32 v196, v196, v212, v213
    v_lshlrev_b32 v193, 16, v212
    v_lshlrev_b32 v195, 16, v213
    v_max3_f32 v196, v196, v193, v195
    v_max3_f32 v196, v196, v214, v215
    v_lshlrev_b32 v193, 16, v214
    v_lshlrev_b32 v195, 16, v215
    v_max3_f32 v196, v196, v193, v195
    v_max3_f32 v196, v196, v216, v217
    v_lshlrev_b32 v193, 16, v216
    v_lshlrev_b32 v195, 16, v217
    v_max3_f32 v196, v196, v193, v195
    v_max3_f32 v196, v196, v218, v219
    v_lshlrev_b32 v193, 16, v218
    v_lshlrev_b32 v195, 16, v219
    v_max3_f32 v196, v196, v193, v195
    v_max3_f32 v196, v196, v220, v221
    v_lshlrev_b32 v193, 16, v220
    v_lshlrev_b32 v195, 16, v221
    v_max3_f32 v196, v196, v193, v195
    v_max3_f32 v196, v196, v222, v223
    v_lshlrev_b32 v193, 16, v222
    v_lshlrev_b32 v195, 16, v223
    v_max3_f32 v196, v196, v193, v195
    v_max3_f32 v196, v196, v224, v225
    v_lshlrev_b32 v193, 16, v224
    v_lshlrev_b32 v195, 16, v225
    v_max3_f32 v196, v196, v193, v195
    v_max3_f32 v196, v196, v226, v227
    v_lshlrev_b32 v193, 16, v226
    v_lshlrev_b32 v195, 16, v227
    v_max3_f32 v196, v196, v193, v195
    v_max3_f32 v196, v196, v228, v229
    v_lshlrev_b32 v193, 16, v228
    v_lshlrev_b32 v195, 16, v229
    v_max3_f32 v196, v196, v193, v195
    v_max3_f32 v196, v196, v230, v231
    v_lshlrev_b32 v193, 16, v230
    v_lshlrev_b32 v195, 16, v231
    v_max3_f32 v196, v196, v193, v195
    v_max3_f32 v196, v196, v232, v233
    v_lshlrev_b32 v193, 16, v232
    v_lshlrev_b32 v195, 16, v233
    v_max3_f32 v196, v196, v193, v195
    v_max3_f32 v196, v196, v234, v235
    v_lshlrev_b32 v193, 16, v234
    v_lshlrev_b32 v195, 16, v235
    v_max3_f32 v196, v196, v193, v195
    s_nop 1
    v_max_f32_dpp v196, v196, v196 row_ror:8 row_mask:0xf bank_mask:0xf
    s_nop 1
    v_max_f32_dpp v196, v196, v196 row_ror:4 row_mask:0xf bank_mask:0xf
    s_nop 1
    v_max_f32_dpp v196, v196, v196 row_ror:2 row_mask:0xf bank_mask:0xf
    s_nop 1
    v_max_f32_dpp v196, v196, v196 row_ror:1 row_mask:0xf bank_mask:0xf
    v_mov_b32 v193, v196
    s_nop 1
    v_permlane16_swap_b32 v196, v193
    s_nop 1
    v_max_f32 v196, v196, v193
    v_mov_b32 v193, v196
    s_nop 1
    v_permlane32_swap_b32 v196, v193
    s_nop 1
    v_max_f32 v196, v196, v193
    v_and_b32 v196, 0xffff0000, v196
    v_or_b32 v196, 1, v196
    s_lshl_b32 s60, s5, 2
    s_add_u32 s60, s60, s65
    s_mov_b64 exec, 1
    s_waitcnt vmcnt(0)
    buffer_store_dword v196, off, s[40:43], s60 offset:1024 sc1
L_pubx_37:
    s_mov_b64 exec, -1
    s_branch L_next2
L_claim:
    ds_read_b128 v[192:195], v189 offset:2496
    s_waitcnt lgkmcnt(0)
    v_readfirstlane_b32 s18, v192
    v_readfirstlane_b32 s19, v193
    v_readfirstlane_b32 s20, v194
    v_readfirstlane_b32 s21, v195
    s_cmp_eq_u32 s18, 0
    s_cbranch_scc1 L_ckst_48
    s_cmp_eq_u32 s18, 4
    s_cbranch_scc1 L_cwr_50
    s_cmp_lg_u32 s18, 1
    s_cbranch_scc1 L_cl_44
    v_and_b32 v197, 7, v1
    v_lshlrev_b32 v197, 2, v197
    s_mov_b32 s64, 0
L_cw_53:
    buffer_load_dword v196, v197, s[40:43], s65 offen offset:1024 sc1
    global_load_dword v198, v189, s[36:37] sc1
    s_waitcnt vmcnt(0)
    v_cmp_eq_u32 vcc, 0, v196
    s_cbranch_vccnz L_cw_54
    v_cmp_gt_u32 vcc, 0x40000000, v198
    s_cbranch_vccz L_cw_55
L_cw_54:
    s_add_u32 s64, s64, 1
    s_cmp_lt_u32 s64, 30000
    s_cbranch_scc1 L_cw_53
L_cw_55:
    v_and_b32 v196, -2, v196
    s_nop 1
    v_max_f32_dpp v196, v196, v196 row_half_mirror row_mask:0xf bank_mask:0xf
    s_nop 1
    v_max_f32_dpp v196, v196, v196 quad_perm:[1,0,3,2] row_mask:0xf bank_mask:0xf
    s_nop 1
    v_max_f32_dpp v196, v196, v196 quad_perm:[2,3,0,1] row_mask:0xf bank_mask:0xf
    v_cmp_lt_u32 vcc, 0x402007ff, v198
    v_or_b32 v199, 0x2000, v196
    s_nop 0
    v_cndmask_b32 v196, v196, v199, vcc
    ds_write_b32 v197, v196 offset:34848
    s_mov_b32 s18, 2
L_cl_44:
    s_lshr_b32 s63, s21, 1
    s_xor_b32 s63, s63, s18
    s_and_b32 s63, s63, 1
    s_lshl_b32 s62, s63, 4
    s_add_u32 s61, s65, 512
    s_sub_u32 s26, 64, s20
    s_lshr_b32 s26, s26, 4
    s_max_u32 s26, s26, 4
    s_min_u32 s26, s26, 24
    s_branch L_cvq_49
L_ckst_48:
    s_xor_b32 s62, s2, 4
    s_lshl_b32 s62, s62, 7
    s_add_u32 s62, s62, 0x50000
    buffer_load_dword v193, off, s[40:43], s62 sc1
    global_load_dword v194, v189, s[36:37] sc1
    s_cmp_gt_u32 s21, 0xf0ff
    s_cbranch_scc1 L_ckdry_47
    s_and_b32 s63, s21, 1
    s_lshl_b32 s61, s63, 8
    s_add_u32 s61, s61, s65
    s_cmp_le_u32 s20, 32
    s_cselect_b32 s26, 16, 8
    s_mov_b32 s62, 0
L_cvq_49:
    s_lshl_b32 s60, s26, s62
    v_mov_b32 v192, s60
    s_mov_b64 exec, 1
    buffer_atomic_add v192, off, s[40:43], s61 sc0 sc1
    s_mov_b64 exec, -1
    s_xor_b32 s61, s62, 16
    s_waitcnt vmcnt(0)
    v_readfirstlane_b32 s60, v192
    s_lshr_b32 s100, s60, s61
    s_and_b32 s100, s100, 0xffff
    s_lshr_b32 s60, s60, s62
    s_and_b32 s60, s60, 0xffff
    s_cmp_eq_u32 s18, 3
    s_cselect_b32 s100, 64, s100
    s_cmp_lt_u32 s17, 64
    s_cselect_b32 s100, 64, s100
    s_cmp_lt_u32 s60, 64
    s_cbranch_scc1 L_cok_45
    s_cmp_eq_u32 s18, 0
    s_cbranch_scc1 L_ckdry_47
    s_mov_b32 s18, 3
    s_mov_b32 s20, s100
    s_cmp_lt_u32 s20, 64
    s_cbranch_scc1 L_cl_44
L_cend_52:
    s_mov_b32 s26, 16
    v_mov_b32 v196, 0x40600003
    s_branch L_cfin_46
L_cok_45:
    s_add_u32 s20, s60, s26
    s_min_u32 s20, s20, 64
    s_sub_u32 s26, s20, s60
    v_add_u32 v197, s60, v1
    v_lshrrev_b32 v199, 5, v197
    v_and_b32 v198, 7, v197
    v_lshl_add_u32 v199, v199, 3, v198
    v_add_u32 v199, 112, v199
    v_bfe_u32 v198, v197, 3, 2
    v_lshlrev_b32 v196, 19, v198
    v_xor_b32 v198, s63, v198
    v_and_b32 v198, 1, v198
    v_lshl_or_b32 v196, v198, 11, v196
    v_and_b32 v198, 3, v199
    v_lshl_or_b32 v196, v198, 9, v196
    v_lshrrev_b32 v198, 2, v199
    v_lshl_or_b32 v196, v198, 14, v196
    s_lshr_b32 s62, s21, 8
    v_add_u32 v198, s62, v1
    v_lshl_or_b32 v196, v198, 22, v196
    s_cmp_eq_u32 s18, 0
    s_cbranch_scc1 L_ckk_56
    s_lshl_b32 s62, s62, 5
    s_add_u32 m0, s62, 0x6800
    s_lshl_b32 s63, s63, 13
    s_lshl_b32 s60, s60, 5
    s_add_u32 s60, s60, s63
    s_add_u32 s60, s60, s16
    s_lshl_b32 s61, s26, 1
    v_lshlrev_b32 v198, 4, v1
    v_or_b32 v196, 1, v196
    v_cmpx_gt_u32 vcc, s61, v1
    s_nop 4
    buffer_load_dwordx4 v198, s[40:43], s60 offen sc1 nt lds
    s_mov_b64 exec, -1
    s_mov_b32 s61, 4
    s_mov_b32 s62, 20
    s_cmp_eq_u32 s20, 64
    s_cselect_b32 s20, s100, s20
    s_cselect_b32 s18, 3, s18
    s_cmp_lt_u32 s20, s17
    s_cbranch_scc1 L_ctg_57
    v_cmp_gt_u32 vcc, s26, v1
    v_mov_b32 v198, 0x40600003
    s_add_u32 s26, s26, 16
    v_cndmask_b32 v196, v198, v196, vcc
    s_branch L_cfin_46
L_ckk_56:
    v_readfirstlane_b32 s67, v194
    s_and_b32 s66, s21, 2
    s_mul_i32 s66, s66, 36
    s_bitcmp1_b32 s21, 2
    s_cselect_b32 s64, 32, 0
    s_or_b32 s66, s66, s64
    s_cmp_eq_u32 s19, 80
    s_cselect_b32 s66, s66, 0
    s_cmp_lt_u32 s67, 0x40000000
    s_cbranch_scc1 L_pf_58
    s_and_b32 s67, s67, 0x7ff
    s_cmp_gt_u32 s67, 1024
    s_cselect_b32 s67, 32, 0
    s_or_b32 s66, s66, 128
    s_cmp_lg_u32 s67, s64
    s_cselect_b32 s66, s66, 0
L_pf_58:
    v_or_b32 v198, s66, v196
    v_cmp_eq_u32 vcc, 4, v1
    s_nop 1
    v_cndmask_b32 v196, v196, v198, vcc
    s_lshr_b32 s62, s62, 3
    s_lshr_b32 s61, s26, 3
    v_add_lshl_u32 v198, s62, v1, 2
    v_lshl_add_u32 v199, v1, 3, s60
    v_cmpx_gt_u32 vcc, s61, v1
    ds_write_b32 v198, v199 offset:2280
    s_mov_b64 exec, -1
    s_mov_b32 s61, 10
    s_mov_b32 s62, 4
L_ctg_57:
    s_lshl_b32 s63, s26, 8
    s_add_u32 s21, s21, s63
    s_sub_u32 s61, s26, s61
    s_max_i32 s61, s61, 0
    v_or_b32 v198, s62, v196
    v_cmp_eq_u32 vcc, s61, v1
    s_nop 1
    v_cndmask_b32 v196, v196, v198, vcc
L_cfin_46:
    v_add_u32 v197, s19, v1
    v_lshlrev_b32 v197, 2, v197
    s_add_u32 s19, s19, s26
    v_mov_b32 v192, s18
    v_mov_b32 v193, s19
    v_mov_b32 v194, s20
    v_mov_b32 v195, s21
    ds_write_b128 v189, v[192:195] offset:2496
    v_cmpx_gt_u32 vcc, s26, v1
    ds_write_b32 v197, v196 offset:22528
    s_mov_b64 exec, -1
    s_branch L_cout_51
L_ckdry_47:
    s_mov_b32 s64, 0
    s_branch L_tc_60
L_tl_59:
    global_load_dword v194, v189, s[36:37] sc1
L_tc_60:
    s_waitcnt vmcnt(0)
    v_readfirstlane_b32 s63, v194
    s_cmp_ge_u32 s63, 0x40000000
    s_cbranch_scc1 L_td_61
    s_add_u32 s64, s64, 1
    s_cmp_lt_u32 s64, 30000
    s_cbranch_scc1 L_tl_59
L_td_61:
    v_readfirstlane_b32 s67, v194
    s_and_b32 s66, s21, 2
    s_mul_i32 s66, s66, 36
    s_bitcmp1_b32 s21, 2
    s_cselect_b32 s64, 32, 0
    s_or_b32 s66, s66, s64
    s_cmp_eq_u32 s19, 80
    s_cselect_b32 s66, s66, 0
    s_cmp_lt_u32 s67, 0x40000000
    s_cbranch_scc1 L_pf_62
    s_and_b32 s67, s67, 0x7ff
    s_cmp_gt_u32 s67, 1024
    s_cselect_b32 s67, 32, 0
    s_or_b32 s66, s66, 128
    s_cmp_lg_u32 s67, s64
    s_cselect_b32 s66, s66, 0
L_pf_62:
    v_readfirstlane_b32 s20, v193
    s_lshr_b32 s60, s21, 8
    s_and_b32 s61, s21, 1
    s_lshl_b32 s61, s61, 13
    s_add_u32 s61, s61, s16
    v_mov_b32 v198, s60
    v_mov_b32 v199, s61
    ds_write_b64 v189, v[198:199] offset:2320
    s_and_b32 s63, s63, 0x7ff
    s_cmp_gt_u32 s63, 1024
    s_cselect_b32 s63, 4, 0
    s_xor_b32 s63, s63, s21
    s_lshr_b32 s63, s63, 1
    s_and_b32 s63, s63, s21
    s_and_b32 s63, s63, 2
    s_and_b32 s21, s21, 1
    s_mul_i32 s21, s21, 3
    s_xor_b32 s21, s21, s63
    s_or_b32 s21, s21, 0x18000
    s_mov_b32 s26, 32
    s_lshr_b32 s60, s101, 2
    s_or_b32 s60, s60, 1
    v_lshl_or_b32 v196, v1, 22, s60
    v_and_b32 v198, 3, v1
    v_lshl_or_b32 v196, v198, 9, v196
    v_lshrrev_b32 v198, 2, v1
    v_lshl_or_b32 v196, v198, 14, v196
    v_or_b32 v198, s66, v196
    v_cmp_eq_u32 vcc, 4, v1
    s_nop 1
    v_cndmask_b32 v196, v196, v198, vcc
    s_lshr_b32 s63, s21, 1
    s_xor_b32 s62, s63, s21
    s_and_b32 s62, s62, 1
    s_cbranch_scc0 L_cloc_63
    s_cmp_eq_u32 s20, s53
    s_cbranch_scc1 L_crem_64
    v_cmp_eq_u32 vcc, 20, v1
    s_mov_b32 s18, 4
    v_or_b32 v198, 4, v196
    v_cndmask_b32 v196, v196, v198, vcc
    s_branch L_cfin_46
L_cwr_50:
    s_xor_b32 s61, s2, 4
    s_lshl_b32 s61, s61, 7
    s_add_u32 s61, s61, 0x50000
    s_mov_b32 s64, 0
L_sw_65:
    buffer_load_dword v192, off, s[40:43], s61 offset:0 sc1
    s_waitcnt vmcnt(0)
    v_readfirstlane_b32 s60, v192
    s_cmp_eq_u32 s60, s53
    s_cbranch_scc1 L_swd_66
    s_add_u32 s64, s64, 1
    s_cmp_lt_u32 s64, 30000
    s_cbranch_scc1 L_sw_65
L_swd_66:
    s_mov_b32 s26, 0
L_crem_64:
    s_xor_b32 s61, s2, 4
    s_lshr_b32 s62, s61, 0
    s_lshl_b32 s62, s62, 12
    s_and_b32 s61, s61, 0
    s_lshl_b32 s61, s61, 8
    s_add_u32 s61, s61, s62
    s_add_u32 s61, s61, 0x280000
    v_lshrrev_b32 v199, 4, v1
    v_lshlrev_b32 v199, 8, v199
    v_and_b32 v198, 15, v1
    v_lshl_add_u32 v198, v198, 4, v199
    s_mov_b32 m0, 0x8c00
    s_nop 0
    buffer_load_dwordx4 v198, s[40:43], s61 offen sc1 nt lds
    s_add_u32 s61, s61, 0x400
    s_mov_b32 m0, 0x9000
    s_nop 0
    buffer_load_dwordx4 v198, s[40:43], s61 offen sc1 nt lds
    s_add_u32 s61, s61, 0x400
    s_mov_b32 exec_lo, 0xffffffff
    s_mov_b32 exec_hi, 0x0
    s_mov_b32 m0, 0x9400
    s_nop 0
    buffer_load_dwordx4 v198, s[40:43], s61 offen sc1 nt lds
    s_add_u32 s61, s61, 0x400
    s_mov_b64 exec, -1
    s_lshr_b32 s63, s21, 1
    s_mov_b32 s62, 0x40000000
L_cloc_63:
    v_add_u32 v197, s19, v1
    v_lshlrev_b32 v198, 2, v197
    v_add_lshl_u32 v197, v197, s26, 2
    v_mov_b32 v200, v197
    v_cmpx_gt_u32 vcc, s26, v1
    ds_write_b32 v198, v196 offset:22528
    s_mov_b64 exec, -1
    s_add_u32 s19, s19, s26
    s_xor_b32 s63, s63, s5
    s_and_b32 s63, s63, 1
    s_lshl_b32 s63, s63, 11
    s_lshr_b32 s60, s101, 21
    s_lshl_b32 s60, s60, 19
    s_or_b32 s63, s63, s60
    s_or_b32 s63, s63, s62
    s_or_b32 s63, s63, 1
    s_mov_b32 s62, 8
    s_add_u32 s19, s19, 80
    v_mov_b32 v192, 1
    v_mov_b32 v193, s19
    v_mov_b32 v194, 0
    v_mov_b32 v195, s21
    ds_write_b128 v189, v[192:195] offset:2496
    v_add_u32 v199, 32, v1
    v_lshl_or_b32 v196, v199, 22, s63
    v_and_b32 v198, 3, v199
    v_lshl_or_b32 v196, v198, 9, v196
    v_lshrrev_b32 v198, 2, v199
    v_lshl_or_b32 v196, v198, 14, v196
    v_or_b32 v198, s62, v196
    v_cmp_eq_u32 vcc, 8, v1
    s_nop 1
    v_cndmask_b32 v196, v196, v198, vcc
    v_or_b32 v198, 16, v196
    v_cmp_eq_u32 vcc, 20, v1
    s_nop 1
    v_cndmask_b32 v196, v196, v198, vcc
    ds_write_b32 v197, v196 offset:22528
    v_add_u32 v199, 96, v1
    v_lshl_or_b32 v196, v199, 22, s63
    v_and_b32 v198, 3, v199
    v_lshl_or_b32 v196, v198, 9, v196
    v_lshrrev_b32 v198, 2, v199
    v_lshl_or_b32 v196, v198, 14, v196
    v_or_b32 v198, 4, v196
    v_cmp_eq_u32 vcc, 4, v1
    s_nop 1
    v_cndmask_b32 v196, v196, v198, vcc
    s_mov_b32 exec_lo, 0xffff
    s_mov_b32 exec_hi, 0x0
    ds_write_b32 v200, v196 offset:22784
    s_mov_b64 exec, -1
L_cout_51:
    s_nop 3
    s_bitcmp1_b32 s68, 2
    s_cbranch_scc1 L_disp
    s_branch L_fh2
L_notk:
    s_cmp_eq_u32 s69, 3
    s_cbranch_scc1 L_sdone
    s_bitcmp1_b32 s27, 4
    s_cbranch_scc1 L_f0_67
    s_waitcnt vmcnt(2)
    buffer_load_dwordx4 v[64:67], v2, s[12:15], s48 offen offset:1024 nt
    buffer_load_dwordx4 v[68:71], v2, s[12:15], s48 offen offset:1280 nt
L_b0_69:
    s_waitcnt lgkmcnt(0)
    v_cmp_eq_u32 vcc, -1, v184
    s_cbranch_vccnz L_uslow_72
L_uback_73:
    v_lshlrev_b32 v32, v190, v184
    v_and_b32 v32, 0xffff0000, v32
    v_cmp_lt_f32 vcc, s51, v32
    s_cbranch_vccnz L_resc_75
L_back_76:
    v_fma_f32 v33, v32, s52, v25
    v_exp_f32 v33, v33
    s_nop 0
    v_cvt_pk_bf16_f32 v34, v33, v33
    v_add_f32 v24, v24, v33
    s_nop 0
    v_and_b32_dpp v40, v34, v4 row_newbcast:0 row_mask:0xf bank_mask:0xf
    v_and_b32_dpp v41, v34, v5 row_newbcast:0 row_mask:0xf bank_mask:0xf
    v_and_b32_dpp v42, v34, v6 row_newbcast:0 row_mask:0xf bank_mask:0xf
    v_and_b32_dpp v43, v34, v7 row_newbcast:0 row_mask:0xf bank_mask:0xf
    v_and_b32_dpp v44, v34, v4 row_newbcast:4 row_mask:0xf bank_mask:0xf
    v_and_b32_dpp v45, v34, v5 row_newbcast:4 row_mask:0xf bank_mask:0xf
    v_and_b32_dpp v46, v34, v6 row_newbcast:4 row_mask:0xf bank_mask:0xf
    v_and_b32_dpp v47, v34, v7 row_newbcast:4 row_mask:0xf bank_mask:0xf
    v_and_b32_dpp v176, v34, v4 row_newbcast:8 row_mask:0xf bank_mask:0xf
    v_and_b32_dpp v177, v34, v5 row_newbcast:8 row_mask:0xf bank_mask:0xf
    v_and_b32_dpp v178, v34, v6 row_newbcast:8 row_mask:0xf bank_mask:0xf
    v_and_b32_dpp v179, v34, v7 row_newbcast:8 row_mask:0xf bank_mask:0xf
    v_and_b32_dpp v180, v34, v4 row_newbcast:12 row_mask:0xf bank_mask:0xf
    v_and_b32_dpp v181, v34, v5 row_newbcast:12 row_mask:0xf bank_mask:0xf
    v_and_b32_dpp v182, v34, v6 row_newbcast:12 row_mask:0xf bank_mask:0xf
    v_and_b32_dpp v183, v34, v7 row_newbcast:12 row_mask:0xf bank_mask:0xf
    v_mfma_f32_16x16x32_bf16 v[16:19], v[40:43], v[48:51], v[16:19]
    v_mfma_f32_16x16x32_bf16 v[20:23], v[40:43], v[52:55], v[20:23]
    s_bitcmp1_b32 s27, 4
    s_cbranch_scc1 L_f1_68
    s_waitcnt vmcnt(2)
    buffer_load_dwordx4 v[72:75], v2, s[12:15], s48 offen offset:1536 nt
    buffer_load_dwordx4 v[76:79], v2, s[12:15], s48 offen offset:1792 nt
L_b1_70:
    v_mov_b32 v3, 4
    s_mov_b64 exec, 1
    ds_add_rtn_u32 v3, v189, v3 offset:2308
    s_mov_b64 exec, -1
    v_mfma_f32_16x16x32_bf16 v[16:19], v[44:47], v[56:59], v[16:19]
    v_mfma_f32_16x16x32_bf16 v[20:23], v[44:47], v[60:63], v[20:23]
    s_waitcnt lgkmcnt(0)
    s_mov_b64 exec, 1
    ds_read_b32 v188, v3 offset:22528
    s_mov_b64 exec, -1
    s_waitcnt lgkmcnt(0)
    v_readfirstlane_b32 s68, v188
    s_cmp_eq_u32 s68, -1
    s_cbranch_scc1 L_spin_78
L_rb_77:
    s_and_b32 s69, s68, 3
    s_and_b32 s49, s68, 0x3ffe00
    s_lshl_b32 s49, s49, 2
    s_lshr_b32 s60, s68, 17
    s_and_b32 s60, s60, 0x7fe0
    v_add_u32 v185, s60, v187
    s_cmp_eq_u32 s69, 0
    s_cselect_b32 s92, s8, s12
    s_cselect_b32 s93, s9, s13
    ds_read_b32 v184, v185
    s_bitcmp1_b32 s68, 4
    s_cbranch_scc1 L_fh_71
    s_waitcnt vmcnt(2)
    buffer_load_dwordx4 v[48:51], v2, s[92:95], s49 offen offset:0 nt
    buffer_load_dwordx4 v[52:55], v2, s[92:95], s49 offen offset:256 nt
    v_mfma_f32_16x16x32_bf16 v[16:19], v[176:179], v[64:67], v[16:19]
    v_mfma_f32_16x16x32_bf16 v[20:23], v[176:179], v[68:71], v[20:23]
    s_waitcnt vmcnt(2)
    buffer_load_dwordx4 v[56:59], v2, s[92:95], s49 offen offset:512 nt
    buffer_load_dwordx4 v[60:63], v2, s[92:95], s49 offen offset:768 nt
    v_mfma_f32_16x16x32_bf16 v[16:19], v[180:183], v[72:75], v[16:19]
    v_mfma_f32_16x16x32_bf16 v[20:23], v[180:183], v[76:79], v[20:23]
    s_branch L_next
L_f0_67:
    s_waitcnt vmcnt(6)
    s_branch L_b0_69
L_f1_68:
    s_waitcnt vmcnt(4)
    s_branch L_b1_70
L_fh_71:
    buffer_load_dwordx4 v[48:51], v2, s[92:95], s49 offen offset:0 nt
    buffer_load_dwordx4 v[52:55], v2, s[92:95], s49 offen offset:256 nt
    buffer_load_dwordx4 v[56:59], v2, s[92:95], s49 offen offset:512 nt
    buffer_load_dwordx4 v[60:63], v2, s[92:95], s49 offen offset:768 nt
    s_bitcmp0_b32 s68, 2
    s_cbranch_scc1 L_fh2
    s_bitset0_b32 s68, 2
    s_branch L_claim
L_fh2:
    s_waitcnt vmcnt(6)
    v_mfma_f32_16x16x32_bf16 v[16:19], v[176:179], v[64:67], v[16:19]
    v_mfma_f32_16x16x32_bf16 v[20:23], v[176:179], v[68:71], v[20:23]
    buffer_load_dwordx4 v[64:67], v2, s[92:95], s49 offen offset:1024 nt
    buffer_load_dwordx4 v[68:71], v2, s[92:95], s49 offen offset:1280 nt
    s_waitcnt vmcnt(6)
    v_mfma_f32_16x16x32_bf16 v[16:19], v[180:183], v[72:75], v[16:19]
    v_mfma_f32_16x16x32_bf16 v[20:23], v[180:183], v[76:79], v[20:23]
    buffer_load_dwordx4 v[72:75], v2, s[92:95], s49 offen offset:1536 nt
    buffer_load_dwordx4 v[76:79], v2, s[92:95], s49 offen offset:1792 nt
    s_branch L_next
L_sdone:
    s_waitcnt lgkmcnt(0)
    v_readfirstlane_b32 s26, v184
    v_fma_f32 v30, -v184, s52, -v25
    v_add_f32_dpp v24, v24, v24 row_ror:8 row_mask:0xf bank_mask:0xf
    v_exp_f32 v37, v30
    v_lshlrev_b32 v31, 4, v1
    v_add_f32_dpp v24, v24, v24 row_ror:4 row_mask:0xf bank_mask:0xf
    s_lshl_b32 s60, s3, 10
    v_mov_b32 v30, v24
    v_permlane32_swap_b32 v16, v20
    v_permlane32_swap_b32 v17, v21
    v_permlane16_swap_b32 v24, v30
    v_add_f32 v24, v24, v30
    v_mov_b32 v30, v24
    v_permlane32_swap_b32 v18, v22
    v_permlane32_swap_b32 v19, v23
    v_permlane32_swap_b32 v24, v30
    v_mul_f32 v16, v16, v37
    v_mul_f32 v17, v17, v37
    v_mul_f32 v18, v18, v37
    v_mul_f32 v19, v19, v37
    v_add_u32 v32, s60, v31
    ds_write_b128 v32, v[16:19] offset:8192
    s_and_b32 s26, s26, 0x2000
    s_add_u32 s40, s40, s26
    s_addc_u32 s41, s41, 0
    v_add_f32 v24, v24, v30
    s_lshl_b32 s60, s3, 2
    v_mul_f32 v24, v24, v37
    v_mov_b32 v30, s60
    v_mov_b32 v33, 1
    s_mov_b64 exec, 1
    ds_write_b32 v30, v24 offset:2560
    s_mov_b64 exec, 1
    ds_add_rtn_u32 v33, v189, v33 offset:2328
    s_mov_b64 exec, -1
    ds_read_b128 v[80:83], v31 offset:8192
    ds_read_b128 v[84:87], v31 offset:9216
    ds_read_b128 v[88:91], v31 offset:10240
    ds_read_b128 v[92:95], v31 offset:11264
    ds_read_b128 v[96:99], v31 offset:12288
    ds_read_b128 v[100:103], v31 offset:13312
    ds_read_b128 v[104:107], v31 offset:14336
    ds_read_b128 v[108:111], v31 offset:15360
    v_and_b32 v30, 1, v1
    v_bfe_u32 v26, v1, 4, 1
    v_lshlrev_b32 v30, 4, v30
    v_lshl_add_u32 v30, v26, 3, v30
    ds_read_b64 v[42:43], v30 offset:2560
    s_and_b32 s60, s6, 7
    s_lshl1_add_u32 s60, s60, s7
    s_lshr_b32 s61, s6, 3
    s_lshl1_add_u32 s60, s60, s61
    s_lshl_b32 s60, s60, 13
    s_mul_i32 s61, s5, 640
    s_add_u32 s60, s60, s61
    s_add_u32 s60, s60, 0x80000
    v_and_b32 v30, 0xf0, v31
    v_lshl_add_u32 v30, v26, 9, v30
    v_lshrrev_b32 v26, 5, v1
    v_lshl_add_u32 v30, v26, 8, v30
    s_waitcnt lgkmcnt(7)
    v_readfirstlane_b32 s62, v33
    v_pk_add_f32 v[80:81], v[80:81], v[84:85]
    v_pk_add_f32 v[82:83], v[82:83], v[86:87]
    s_waitcnt lgkmcnt(6)
    v_pk_add_f32 v[80:81], v[80:81], v[88:89]
    v_pk_add_f32 v[82:83], v[82:83], v[90:91]
    s_waitcnt lgkmcnt(5)
    v_pk_add_f32 v[80:81], v[80:81], v[92:93]
    v_pk_add_f32 v[82:83], v[82:83], v[94:95]
    s_waitcnt lgkmcnt(4)
    v_pk_add_f32 v[80:81], v[80:81], v[96:97]
    v_pk_add_f32 v[82:83], v[82:83], v[98:99]
    s_waitcnt lgkmcnt(3)
    v_pk_add_f32 v[80:81], v[80:81], v[100:101]
    v_pk_add_f32 v[82:83], v[82:83], v[102:103]
    s_waitcnt lgkmcnt(2)
    v_pk_add_f32 v[80:81], v[80:81], v[104:105]
    v_pk_add_f32 v[82:83], v[82:83], v[106:107]
    s_waitcnt lgkmcnt(1)
    v_pk_add_f32 v[80:81], v[80:81], v[108:109]
    v_pk_add_f32 v[82:83], v[82:83], v[110:111]
    v_cvt_pk_bf16_f32 v40, v80, v81
    v_cvt_pk_bf16_f32 v41, v82, v83
    s_cmp_eq_u32 s62, 7
    s_waitcnt lgkmcnt(0)
    v_permlane16_swap_b32 v40, v42
    v_permlane16_swap_b32 v41, v43
    s_cselect_b32 exec_lo, 0x3ffff, 0
    s_cselect_b32 exec_hi, 0xffff, 0
    buffer_store_dwordx4 v[40:43], v30, s[40:43], s60 offen sc1
    s_mov_b64 exec, -1
    s_cmp_eq_u32 s54, 0
    s_cbranch_scc1 L_exit
    v_and_b32 v26, 15, v1
    v_lshrrev_b32 v27, 4, v1
    v_bfe_u32 v28, v1, 2, 2
    v_and_b32 v29, 3, v1
    v_lshlrev_b32 v34, 2, v1
    v_mov_b32 v33, 1
    s_cmp_eq_u32 s54, 2
    s_cbranch_scc1 L_f1
    s_cmp_eq_u32 s54, 3
    s_cbranch_scc1 L_f2
    s_mul_i32 s63, s55, 9363
    s_lshr_b32 s63, s63, 16
    s_mul_i32 s61, s63, 7
    s_sub_u32 s61, s55, s61
    s_lshr_b32 s68, s3, 2
    s_and_b32 s69, s3, 3
    s_lshl_b32 s60, s3, 13
    s_add_u32 s60, s60, 0xb800
    v_lshl_add_u32 v30, v27, 3, v28
    v_lshlrev_b32 v30, 7, v30
    v_lshl_add_u32 v30, v29, 3, v30
    v_add_u32 v31, s60, v30
    ds_read_b64_tr_b16 v[80:81], v31 offset:0
    ds_read_b64_tr_b16 v[82:83], v31 offset:512
    ds_read_b64_tr_b16 v[84:85], v31 offset:32
    ds_read_b64_tr_b16 v[86:87], v31 offset:544
    ds_read_b64_tr_b16 v[88:89], v31 offset:64
    ds_read_b64_tr_b16 v[90:91], v31 offset:576
    ds_read_b64_tr_b16 v[92:93], v31 offset:96
    ds_read_b64_tr_b16 v[94:95], v31 offset:608
    ds_read_b64_tr_b16 v[96:97], v31 offset:4096
    ds_read_b64_tr_b16 v[98:99], v31 offset:4608
    ds_read_b64_tr_b16 v[100:101], v31 offset:4128
    ds_read_b64_tr_b16 v[102:103], v31 offset:4640
    ds_read_b64_tr_b16 v[104:105], v31 offset:4160
    ds_read_b64_tr_b16 v[106:107], v31 offset:4672
    ds_read_b64_tr_b16 v[108:109], v31 offset:4192
    ds_read_b64_tr_b16 v[110:111], v31 offset:4704
    v_lshrrev_b32 v30, 5, v1
    v_mul_u32_u24 v30, 768, v30
    v_add_u32 v30, v30, v34
    s_lshl_b32 s60, s61, 7
    s_lshl_b32 s62, s63, 12
    s_add_u32 s60, s60, s62
    buffer_load_dword v149, v30, s[44:47], s60 offen
    s_lshl1_add_u32 s62, s63, s68
    s_lshr_b32 s60, s62, 3
    s_and_b32 s62, s62, 7
    s_lshl2_add_u32 s62, s62, s60
    s_lshl_b32 s62, s62, 13
    s_add_u32 s62, s62, 0x80000
    s_lshl_b32 s60, s69, 7
    s_add_u32 s60, s60, s62
    s_cmp_eq_u32 s69, 0
    s_cselect_b32 s62, s62, 0x7ff00000
    s_cselect_b32 s27, 1, 0
    v_mul_u32_u24 v35, 640, v26
    v_lshl_add_u32 v35, v27, 4, v35
    v_and_b32 v30, 8, v26
    v_mul_u32_u24 v30, 1408, v30
    v_add_u32 v35, v35, v30
    v_lshrrev_b32 v30, 5, v1
    v_and_b32 v31, 7, v1
    v_mul_u32_u24 v36, 640, v31
    v_lshl_add_u32 v36, v30, 14, v36
    v_and_b32 v31, 8, v1
    v_lshl_add_u32 v36, v31, 1, v36
    s_lshl_b32 s69, s3, 9
    s_lshl_b32 s68, s68, 2
    v_lshl_add_u32 v28, v30, 7, v34
    v_add_u32 v28, s69, v28
    v_lshlrev_b32 v29, 3, v1
    v_lshlrev_b32 v26, 3, v30
    v_add_u32 v32, s68, v26
    v_lshlrev_b32 v30, 14, v30
    v_and_b32 v27, 0x70, v34
    v_add_u32 v27, v27, v30
    s_mul_i32 s63, s63, 896
    s_lshl_b32 s61, s61, 7
    s_add_u32 s63, s63, s61
    s_add_u32 s63, s63, 0xc4000
    s_barrier
    s_mov_b32 s64, 0
L_poll_80:
    buffer_load_dwordx4 v[120:123], v36, s[40:43], s62 offen offset:512 sc1
    buffer_load_dwordx4 v[112:115], v35, s[40:43], s60 offen offset:0 sc1
    buffer_load_dwordx4 v[116:119], v35, s[40:43], s60 offen offset:64 sc1
    s_waitcnt vmcnt(0)
    v_max_u32 v30, v112, v113
    v_max3_u32 v30, v30, v114, v115
    v_max3_u32 v30, v30, v116, v117
    v_max3_u32 v30, v30, v118, v119
    v_max3_u32 v30, v30, v120, v121
    v_max3_u32 v30, v30, v122, v123
    v_cmp_eq_u32 vcc, -1, v30
    s_cbranch_vccz L_polld_81
    s_mov_b64 exec, vcc
    s_add_u32 s64, s64, 1
    s_cmp_lt_u32 s64, 120000
    s_cbranch_scc1 L_poll_80
L_polld_81:
    s_mov_b64 exec, -1
    s_waitcnt lgkmcnt(0)
    v_mfma_f32_16x16x32_bf16 v[132:135], v[112:115], v[80:83], 0
    v_add_f32 v30, v120, v121
    v_add_f32 v31, v122, v123
    v_mfma_f32_16x16x32_bf16 v[136:139], v[112:115], v[84:87], 0
    v_add_f32 v30, v30, v31
    s_nop 0
    v_mfma_f32_16x16x32_bf16 v[140:143], v[112:115], v[88:91], 0
    v_add_f32_dpp v30, v30, v30 row_ror:8 row_mask:0xf bank_mask:0xf
    s_nop 0
    v_mfma_f32_16x16x32_bf16 v[144:147], v[112:115], v[92:95], 0
    v_add_f32_dpp v30, v30, v30 row_half_mirror row_mask:0xf bank_mask:0xf
    s_nop 0
    v_mfma_f32_16x16x32_bf16 v[132:135], v[116:119], v[96:99], v[132:135]
    v_add_f32_dpp v30, v30, v30 quad_perm:[1,0,3,2] row_mask:0xf bank_mask:0xf
    s_nop 0
    v_mfma_f32_16x16x32_bf16 v[136:139], v[116:119], v[100:103], v[136:139]
    v_add_f32_dpp v30, v30, v30 quad_perm:[2,3,0,1] row_mask:0xf bank_mask:0xf
    v_mfma_f32_16x16x32_bf16 v[140:143], v[116:119], v[104:107], v[140:143]
    v_rcp_f32 v30, v30
    v_mfma_f32_16x16x32_bf16 v[144:147], v[116:119], v[108:111], v[144:147]
    s_mov_b32 exec_lo, s27
    s_mov_b32 exec_hi, s27
    ds_write_b32 v32, v30 offset:2624
    s_mov_b64 exec, -1
    v_add_f32 v132, v132, v133
    v_add_f32 v134, v134, v135
    v_add_f32 v132, v132, v134
    v_add_f32 v136, v136, v137
    v_add_f32 v138, v138, v139
    v_add_f32 v136, v136, v138
    v_lshlrev_b32 v148, 16, v149
    v_and_b32 v149, 0xffff0000, v149
    v_permlane16_swap_b32 v132, v136
    v_add_f32 v140, v140, v141
    v_add_f32 v142, v142, v143
    v_add_f32 v140, v140, v142
    v_add_f32 v132, v132, v136
    v_add_f32 v144, v144, v145
    v_add_f32 v146, v146, v147
    v_add_f32 v144, v144, v146
    ds_write_b32 v28, v132 offset:2816
    s_nop 0
    v_permlane16_swap_b32 v140, v144
    v_add_f32 v140, v140, v144
    ds_write_b32 v28, v140 offset:2944
    s_mov_b64 exec, 1
    ds_add_rtn_u32 v33, v189, v33 offset:2332
    s_mov_b64 exec, -1
    ds_read_b64 v[152:153], v29 offset:2816
    ds_read_b64 v[154:155], v29 offset:3328
    ds_read_b64 v[156:157], v29 offset:3840
    ds_read_b64 v[158:159], v29 offset:4352
    ds_read_b64 v[160:161], v29 offset:4864
    ds_read_b64 v[162:163], v29 offset:5376
    ds_read_b64 v[164:165], v29 offset:5888
    ds_read_b64 v[166:167], v29 offset:6400
    ds_read_b64 v[168:169], v26 offset:2624
    s_waitcnt lgkmcnt(5)
    v_readfirstlane_b32 s60, v33
    v_pk_add_f32 v[152:153], v[152:153], v[154:155]
    v_pk_add_f32 v[156:157], v[156:157], v[158:159]
    v_pk_add_f32 v[152:153], v[152:153], v[156:157]
    s_waitcnt lgkmcnt(1)
    v_pk_add_f32 v[160:161], v[160:161], v[162:163]
    v_pk_add_f32 v[164:165], v[164:165], v[166:167]
    v_pk_add_f32 v[160:161], v[160:161], v[164:165]
    s_waitcnt lgkmcnt(0)
    v_pk_fma_f32 v[148:149], v[152:153], v[168:169], v[148:149] op_sel_hi:[1,0,1]
    v_pk_fma_f32 v[148:149], v[160:161], v[168:169], v[148:149] op_sel:[0,1,0]
    v_cvt_pk_bf16_f32 v40, v148, v149
    s_cmp_eq_u32 s60, 7
    s_cselect_b32 s60, 0x11111111, 0
    v_mov_b32_dpp v41, v40 quad_perm:[1,1,1,1] row_mask:0xf bank_mask:0xf
    v_mov_b32_dpp v42, v40 quad_perm:[2,2,2,2] row_mask:0xf bank_mask:0xf
    v_mov_b32_dpp v43, v40 quad_perm:[3,3,3,3] row_mask:0xf bank_mask:0xf
    s_mov_b32 exec_lo, s60
    s_mov_b32 exec_hi, s60
    buffer_store_dwordx4 v[40:43], v27, s[40:43], s63 offen sc1
    s_mov_b64 exec, -1
    s_branch L_exit
L_f1:
    s_add_u32 s3, s62, 7
    s_and_b32 s3, s3, 7
    s_cmp_lg_u32 s3, 7
    s_cselect_b64 s[92:93], -1, 0
    s_cselect_b32 s68, s3, 0
    s_cselect_b32 s94, 0x01010101, 0
    s_mov_b32 s95, 0
    s_cselect_b64 s[96:97], 1, 0
    s_lshl_b32 s60, s68, 13
    s_add_u32 s60, s60, 0xb800
    v_lshl_add_u32 v30, v27, 3, v28
    v_lshlrev_b32 v30, 7, v30
    v_lshl_add_u32 v30, v29, 3, v30
    v_add_u32 v31, s60, v30
    ds_read_b64_tr_b16 v[80:81], v31 offset:0
    ds_read_b64_tr_b16 v[82:83], v31 offset:512
    ds_read_b64_tr_b16 v[84:85], v31 offset:4096
    ds_read_b64_tr_b16 v[86:87], v31 offset:4608
    ds_read_b64_tr_b16 v[88:89], v31 offset:32
    ds_read_b64_tr_b16 v[90:91], v31 offset:544
    ds_read_b64_tr_b16 v[92:93], v31 offset:4128
    ds_read_b64_tr_b16 v[94:95], v31 offset:4640
    ds_read_b64_tr_b16 v[96:97], v31 offset:64
    ds_read_b64_tr_b16 v[98:99], v31 offset:576
    ds_read_b64_tr_b16 v[100:101], v31 offset:4160
    ds_read_b64_tr_b16 v[102:103], v31 offset:4672
    ds_read_b64_tr_b16 v[104:105], v31 offset:96
    ds_read_b64_tr_b16 v[106:107], v31 offset:608
    ds_read_b64_tr_b16 v[108:109], v31 offset:4192
    ds_read_b64_tr_b16 v[110:111], v31 offset:4704
    ds_read_b64_tr_b16 v[112:113], v31 offset:57344
    ds_read_b64_tr_b16 v[114:115], v31 offset:57856
    ds_read_b64_tr_b16 v[116:117], v31 offset:61440
    ds_read_b64_tr_b16 v[118:119], v31 offset:61952
    ds_read_b64_tr_b16 v[120:121], v31 offset:57376
    ds_read_b64_tr_b16 v[122:123], v31 offset:57888
    ds_read_b64_tr_b16 v[124:125], v31 offset:61472
    ds_read_b64_tr_b16 v[126:127], v31 offset:61984
    ds_read_b64_tr_b16 v[128:129], v31 offset:57408
    ds_read_b64_tr_b16 v[130:131], v31 offset:57920
    ds_read_b64_tr_b16 v[132:133], v31 offset:61504
    ds_read_b64_tr_b16 v[134:135], v31 offset:62016
    ds_read_b64_tr_b16 v[136:137], v31 offset:57440
    ds_read_b64_tr_b16 v[138:139], v31 offset:57952
    ds_read_b64_tr_b16 v[140:141], v31 offset:61536
    ds_read_b64_tr_b16 v[142:143], v31 offset:62048
    v_mov_b32 v208, 0x3f803f80
    v_mov_b32 v209, 0x3f803f80
    v_mov_b32 v210, 0x3f803f80
    v_mov_b32 v211, 0x3f803f80
    v_mul_u32_u24 v35, 896, v26
    v_lshl_add_u32 v35, v27, 4, v35
    v_and_b32 v30, 8, v26
    v_mul_u32_u24 v30, 1152, v30
    v_add_u32 v35, v35, v30
    s_lshl_b32 s60, s3, 3
    v_and_b32 v28, 8, v1
    v_lshlrev_b32 v28, 3, v28
    v_lshl_add_u32 v28, v27, 2, v28
    v_add_u32 v28, s60, v28
    v_lshrrev_b32 v30, 5, v1
    v_lshlrev_b32 v29, 6, v30
    v_lshlrev_b32 v30, 4, v30
    v_and_b32 v36, 0x70, v34
    v_lshl_add_u32 v36, v36, 1, v30
    s_lshl_b32 s60, s3, 10
    v_lshlrev_b32 v27, 4, v1
    v_add_u32 v26, s60, v27
    s_lshl_b32 s60, s68, 7
    s_add_u32 s60, s60, 0xc4000
    s_lshl_b32 s63, s55, 8
    s_add_u32 s63, s63, 0xcc000
    s_mov_b32 s66, 0x00ff00ff
    s_mov_b32 s67, 0xff00ff00
    s_cmp_eq_u32 s3, 7
    s_cbranch_scc1 L_f1go
    s_waitcnt lgkmcnt(0)
    v_mfma_f32_16x16x32_bf16 v[144:147], v[208:211], v[80:83], 0
    v_mfma_f32_16x16x32_bf16 v[144:147], v[208:211], v[84:87], v[144:147]
    v_mfma_f32_16x16x32_bf16 v[148:151], v[208:211], v[88:91], 0
    v_mfma_f32_16x16x32_bf16 v[148:151], v[208:211], v[92:95], v[148:151]
    v_mfma_f32_16x16x32_bf16 v[152:155], v[208:211], v[96:99], 0
    v_mfma_f32_16x16x32_bf16 v[152:155], v[208:211], v[100:103], v[152:155]
    v_mfma_f32_16x16x32_bf16 v[156:159], v[208:211], v[104:107], 0
    v_mfma_f32_16x16x32_bf16 v[156:159], v[208:211], v[108:111], v[156:159]
    v_mfma_f32_16x16x32_bf16 v[160:163], v[208:211], v[112:115], 0
    v_mfma_f32_16x16x32_bf16 v[160:163], v[208:211], v[116:119], v[160:163]
    v_mfma_f32_16x16x32_bf16 v[164:167], v[208:211], v[120:123], 0
    v_mfma_f32_16x16x32_bf16 v[164:167], v[208:211], v[124:127], v[164:167]
    v_mfma_f32_16x16x32_bf16 v[168:171], v[208:211], v[128:131], 0
    v_mfma_f32_16x16x32_bf16 v[168:171], v[208:211], v[132:135], v[168:171]
    v_mfma_f32_16x16x32_bf16 v[172:175], v[208:211], v[136:139], 0
    v_mfma_f32_16x16x32_bf16 v[172:175], v[208:211], v[140:143], v[172:175]
    s_nop 7
    v_mov_b32 v212, v144
    v_mov_b32_dpp v212, v148 quad_perm:[0,1,2,3] row_mask:0xa bank_mask:0xf
    v_mov_b32 v213, v152
    v_mov_b32_dpp v213, v156 quad_perm:[0,1,2,3] row_mask:0xa bank_mask:0xf
    v_mov_b32 v214, v160
    v_mov_b32_dpp v214, v164 quad_perm:[0,1,2,3] row_mask:0xa bank_mask:0xf
    v_mov_b32 v215, v168
    v_mov_b32_dpp v215, v172 quad_perm:[0,1,2,3] row_mask:0xa bank_mask:0xf
    s_barrier
    ds_write_b128 v26, v[212:215] offset:8192
    s_waitcnt lgkmcnt(0)
    s_barrier
    ds_read_b128 v[144:147], v27 offset:8192
    ds_read_b128 v[148:151], v27 offset:9216
    ds_read_b128 v[152:155], v27 offset:10240
    ds_read_b128 v[156:159], v27 offset:11264
    ds_read_b128 v[160:163], v27 offset:12288
    ds_read_b128 v[164:167], v27 offset:13312
    ds_read_b128 v[168:171], v27 offset:14336
    s_waitcnt lgkmcnt(0)
    v_pk_add_f32 v[216:217], v[144:145], v[148:149]
    v_pk_add_f32 v[218:219], v[146:147], v[150:151]
    v_pk_add_f32 v[216:217], v[216:217], v[152:153]
    v_pk_add_f32 v[218:219], v[218:219], v[154:155]
    v_pk_add_f32 v[216:217], v[216:217], v[156:157]
    v_pk_add_f32 v[218:219], v[218:219], v[158:159]
    v_pk_add_f32 v[216:217], v[216:217], v[160:161]
    v_pk_add_f32 v[218:219], v[218:219], v[162:163]
    v_pk_add_f32 v[216:217], v[216:217], v[164:165]
    v_pk_add_f32 v[218:219], v[218:219], v[166:167]
    v_pk_add_f32 v[216:217], v[216:217], v[168:169]
    v_pk_add_f32 v[218:219], v[218:219], v[170:171]
    s_barrier
    s_mov_b32 s64, 0
L_poll_82:
    buffer_load_dwordx4 v[176:179], v35, s[40:43], s60 offen offset:0 sc1
    buffer_load_dwordx4 v[180:183], v35, s[40:43], s60 offen offset:64 sc1
    s_waitcnt vmcnt(0)
    v_max_u32 v30, v176, v177
    v_max3_u32 v30, v30, v178, v179
    v_max3_u32 v30, v30, v180, v181
    v_max3_u32 v30, v30, v182, v183
    v_cmp_eq_u32 vcc, -1, v30
    s_cbranch_vccz L_polld_83
    s_mov_b64 exec, vcc
    s_add_u32 s64, s64, 1
    s_cmp_lt_u32 s64, 120000
    s_cbranch_scc1 L_poll_82
L_polld_83:
    s_mov_b64 exec, -1
L_f1go:
    v_mfma_f32_16x16x32_bf16 v[204:207], v[176:179], v[176:179], 0
    v_mfma_f32_16x16x32_bf16 v[204:207], v[180:183], v[180:183], v[204:207]
    v_dot2_f32_bf16 v32, v176, v208, 0
    v_dot2_f32_bf16 v32, v177, v208, v32
    v_dot2_f32_bf16 v32, v178, v208, v32
    v_dot2_f32_bf16 v32, v179, v208, v32
    v_mfma_f32_16x16x32_bf16 v[144:147], v[176:179], v[80:83], 0
    v_mfma_f32_16x16x32_bf16 v[144:147], v[180:183], v[84:87], v[144:147]
    v_dot2_f32_bf16 v32, v180, v208, v32
    v_dot2_f32_bf16 v32, v181, v208, v32
    v_dot2_f32_bf16 v32, v182, v208, v32
    v_dot2_f32_bf16 v32, v183, v208, v32
    v_mfma_f32_16x16x32_bf16 v[148:151], v[176:179], v[88:91], 0
    v_mfma_f32_16x16x32_bf16 v[148:151], v[180:183], v[92:95], v[148:151]
    v_add_f32 v204, v204, v205
    v_add_f32 v206, v206, v207
    v_add_f32 v204, v204, v206
    v_cndmask_b32 v37, 0, v204, s[66:67]
    v_mfma_f32_16x16x32_bf16 v[152:155], v[176:179], v[96:99], 0
    v_mfma_f32_16x16x32_bf16 v[152:155], v[180:183], v[100:103], v[152:155]
    v_permlane16_swap_b32 v32, v37
    v_add_f32 v32, v32, v37
    v_mov_b32 v37, v32
    v_add_f32 v144, v144, v145
    v_add_f32 v146, v146, v147
    v_add_f32 v144, v144, v146
    v_mfma_f32_16x16x32_bf16 v[156:159], v[176:179], v[104:107], 0
    v_mfma_f32_16x16x32_bf16 v[156:159], v[180:183], v[108:111], v[156:159]
    v_permlane32_swap_b32 v32, v37
    v_add_f32 v32, v32, v37
    v_add_f32 v148, v148, v149
    v_add_f32 v150, v150, v151
    v_add_f32 v148, v148, v150
    v_mfma_f32_16x16x32_bf16 v[160:163], v[176:179], v[112:115], 0
    v_mfma_f32_16x16x32_bf16 v[160:163], v[180:183], v[116:119], v[160:163]
    v_add_f32_dpp v32, v32, v32 row_half_mirror row_mask:0xf bank_mask:0xf
    v_add_f32 v152, v152, v153
    v_add_f32 v154, v154, v155
    v_add_f32 v152, v152, v154
    v_add_f32_dpp v32, v32, v32 quad_perm:[1,0,3,2] row_mask:0xf bank_mask:0xf
    v_permlane16_swap_b32 v144, v148
    v_add_f32 v212, v144, v148
    v_mfma_f32_16x16x32_bf16 v[164:167], v[176:179], v[120:123], 0
    v_mfma_f32_16x16x32_bf16 v[164:167], v[180:183], v[124:127], v[164:167]
    v_add_f32_dpp v32, v32, v32 quad_perm:[2,3,0,1] row_mask:0xf bank_mask:0xf
    v_add_f32 v156, v156, v157
    v_add_f32 v158, v158, v159
    v_add_f32 v156, v156, v158
    v_mfma_f32_16x16x32_bf16 v[168:171], v[176:179], v[128:131], 0
    v_mfma_f32_16x16x32_bf16 v[168:171], v[180:183], v[132:135], v[168:171]
    s_mov_b64 exec, s[94:95]
    ds_write_b32 v28, v32 offset:2624
    s_mov_b64 exec, -1
    v_add_f32 v160, v160, v161
    v_add_f32 v162, v162, v163
    v_add_f32 v160, v160, v162
    v_permlane16_swap_b32 v152, v156
    v_add_f32 v213, v152, v156
    v_mfma_f32_16x16x32_bf16 v[172:175], v[176:179], v[136:139], 0
    v_mfma_f32_16x16x32_bf16 v[172:175], v[180:183], v[140:143], v[172:175]
    v_add_f32 v164, v164, v165
    v_add_f32 v166, v166, v167
    v_add_f32 v164, v164, v166
    v_add_f32 v168, v168, v169
    v_add_f32 v170, v170, v171
    v_add_f32 v168, v168, v170
    v_permlane16_swap_b32 v160, v164
    v_add_f32 v214, v160, v164
    v_add_f32 v172, v172, v173
    v_add_f32 v174, v174, v175
    v_add_f32 v172, v172, v174
    s_mov_b64 exec, s[92:93]
    s_nop 0
    v_permlane16_swap_b32 v168, v172
    v_add_f32 v215, v168, v172
    ds_write_b128 v26, v[212:215] offset:8192
    s_mov_b64 exec, s[96:97]
    ds_add_rtn_u32 v33, v189, v33 offset:2332
    s_mov_b64 exec, -1
    v_mov_b32 v37, 0x3d372713
    s_waitcnt lgkmcnt(0)
    v_readfirstlane_b32 s60, v33
    s_xor_b32 s60, s60, 6
    s_and_b32 s60, s60, s92
    s_cbranch_scc1 L_exit
    ds_read_b128 v[220:223], v29 offset:2624
    ds_read_b128 v[224:227], v29 offset:2640
    ds_read_b128 v[228:231], v29 offset:2656
    ds_read_b128 v[232:235], v29 offset:2672
    ds_read_b128 v[80:83], v27 offset:8192
    ds_read_b128 v[84:87], v27 offset:9216
    ds_read_b128 v[88:91], v27 offset:10240
    ds_read_b128 v[92:95], v27 offset:11264
    ds_read_b128 v[96:99], v27 offset:12288
    ds_read_b128 v[100:103], v27 offset:13312
    ds_read_b128 v[104:107], v27 offset:14336
    s_waitcnt lgkmcnt(9)
    v_pk_add_f32 v[220:221], v[220:221], v[222:223]
    v_pk_add_f32 v[224:225], v[224:225], v[226:227]
    s_waitcnt lgkmcnt(7)
    v_pk_add_f32 v[228:229], v[228:229], v[230:231]
    v_pk_add_f32 v[220:221], v[220:221], v[232:233]
    v_pk_add_f32 v[224:225], v[224:225], v[228:229]
    v_pk_add_f32 v[220:221], v[220:221], v[224:225]
    v_mul_f32 v220, 0x3b124925, v220
    v_mul_f32 v221, 0x3b124925, v221
    v_fma_f32 v221, -v220, v220, v221
    v_max_f32 v221, 0, v221
    v_cvt_pk_bf16_f32 v221, v221, v221
    v_and_b32 v221, 0xffff0000, v221
    v_add_f32 v221, 0x3727c5ac, v221
    v_cvt_pk_bf16_f32 v221, v221, v221
    v_and_b32 v221, 0xffff0000, v221
    v_sqrt_f32 v221, v221
    v_cvt_pk_bf16_f32 v220, v220, v220
    v_and_b32 v220, 0xffff0000, v220
    v_cvt_pk_bf16_f32 v221, v221, v221
    v_and_b32 v221, 0xffff0000, v221
    v_rcp_f32 v221, v221
    s_waitcnt lgkmcnt(0)
    v_pk_add_f32 v[80:81], v[80:81], v[84:85]
    v_pk_add_f32 v[82:83], v[82:83], v[86:87]
    v_pk_add_f32 v[88:89], v[88:89], v[92:93]
    v_pk_add_f32 v[90:91], v[90:91], v[94:95]
    v_pk_add_f32 v[96:97], v[96:97], v[100:101]
    v_pk_add_f32 v[98:99], v[98:99], v[102:103]
    v_pk_add_f32 v[80:81], v[80:81], v[104:105]
    v_pk_add_f32 v[82:83], v[82:83], v[106:107]
    v_pk_add_f32 v[88:89], v[88:89], v[96:97]
    v_pk_add_f32 v[90:91], v[90:91], v[98:99]
    v_pk_add_f32 v[80:81], v[80:81], v[88:89]
    v_pk_add_f32 v[82:83], v[82:83], v[90:91]
    v_fma_f32 v212, -v220, v216, v80
    v_fma_f32 v213, -v220, v217, v81
    v_fma_f32 v214, -v220, v218, v82
    v_fma_f32 v215, -v220, v219, v83
    v_mul_f32 v212, v212, v221
    v_mul_f32 v213, v213, v221
    v_mul_f32 v214, v214, v221
    v_mul_f32 v215, v215, v221
    v_cvt_pk_bf16_f32 v213, v212, v213
    v_cvt_pk_bf16_f32 v215, v214, v215
    v_lshlrev_b32 v212, 16, v213
    v_and_b32 v213, 0xffff0000, v213
    v_mul_f32 v236, v212, v212
    v_mul_f32 v237, v213, v213
    v_fma_f32 v236, v236, v37, 1.0
    v_fma_f32 v237, v237, v37, 1.0
    v_mul_f32 v236, v236, v212
    v_mul_f32 v237, v237, v213
    v_mul_f32 v236, 0xc0135761, v236
    v_mul_f32 v237, 0xc0135761, v237
    v_exp_f32 v236, v236
    v_exp_f32 v237, v237
    v_lshlrev_b32 v214, 16, v215
    v_add_f32 v236, 1.0, v236
    v_add_f32 v237, 1.0, v237
    v_rcp_f32 v236, v236
    v_rcp_f32 v237, v237
    v_and_b32 v215, 0xffff0000, v215
    v_mul_f32 v236, v236, v212
    v_mul_f32 v237, v237, v213
    v_cvt_pk_bf16_f32 v237, v236, v237
    v_lshlrev_b32 v236, 16, v237
    v_and_b32 v237, 0xffff0000, v237
    v_mul_f32 v236, v236, v214
    v_mul_f32 v237, v237, v215
    v_cvt_pk_bf16_f32 v40, v236, v237
    s_and_b32 s61, s92, 0x11111111
    s_nop 0
    v_mov_b32_dpp v41, v40 quad_perm:[1,1,1,1] row_mask:0xf bank_mask:0xf
    v_mov_b32_dpp v42, v40 quad_perm:[2,2,2,2] row_mask:0xf bank_mask:0xf
    v_mov_b32_dpp v43, v40 quad_perm:[3,3,3,3] row_mask:0xf bank_mask:0xf
    s_mov_b32 exec_lo, s61
    s_mov_b32 exec_hi, s61
    buffer_store_dwordx4 v[40:43], v36, s[40:43], s63 offen sc1
    s_mov_b64 exec, -1
    s_cmp_lg_u32 s3, 7
    s_cbranch_scc1 L_exit
    s_waitcnt vmcnt(0)
    s_barrier
    s_barrier
    s_mov_b32 s60, 0xc4000
    s_mov_b64 exec, 0xffff
    s_mov_b32 s64, 0
L_poll_84:
    buffer_load_dwordx2 v[176:177], v35, s[40:43], s60 offen sc1
    s_waitcnt vmcnt(0)
    v_max_u32 v30, v176, v177
    v_cmp_eq_u32 vcc, -1, v30
    s_bcnt1_i32_b64 s26, vcc
    s_cmp_le_u32 s26, 16
    s_cbranch_scc1 L_polld_85
    s_mov_b64 exec, vcc
    s_add_u32 s64, s64, 1
    s_cmp_lt_u32 s64, 120000
    s_cbranch_scc1 L_poll_84
L_polld_85:
    s_mov_b64 exec, -1
    s_barrier
    s_branch L_exit
L_f2:
    s_add_u32 s3, s62, 7
    s_and_b32 s3, s3, 7
    s_cmp_lg_u32 s3, 7
    s_cselect_b64 s[92:93], -1, 0
    s_cselect_b32 s68, s3, 0
    s_lshl_b32 s60, s68, 13
    s_add_u32 s60, s60, 0xb800
    v_and_b32 v30, 1, v28
    v_lshlrev_b32 v30, 5, v30
    v_lshrrev_b32 v31, 1, v28
    v_add_u32 v30, v30, v31
    v_lshl_add_u32 v30, v27, 6, v30
    v_lshlrev_b32 v30, 5, v30
    v_lshl_add_u32 v30, v29, 3, v30
    v_add_u32 v31, s60, v30
    ds_read_b64_tr_b16 v[80:81], v31 offset:0
    ds_read_b64_tr_b16 v[82:83], v31 offset:64
    ds_read_b64_tr_b16 v[84:85], v31 offset:128
    ds_read_b64_tr_b16 v[86:87], v31 offset:192
    ds_read_b64_tr_b16 v[88:89], v31 offset:256
    ds_read_b64_tr_b16 v[90:91], v31 offset:320
    ds_read_b64_tr_b16 v[92:93], v31 offset:384
    ds_read_b64_tr_b16 v[94:95], v31 offset:448
    ds_read_b64_tr_b16 v[96:97], v31 offset:512
    ds_read_b64_tr_b16 v[98:99], v31 offset:576
    ds_read_b64_tr_b16 v[100:101], v31 offset:640
    ds_read_b64_tr_b16 v[102:103], v31 offset:704
    ds_read_b64_tr_b16 v[104:105], v31 offset:768
    ds_read_b64_tr_b16 v[106:107], v31 offset:832
    ds_read_b64_tr_b16 v[108:109], v31 offset:896
    ds_read_b64_tr_b16 v[110:111], v31 offset:960
    s_mov_b32 s56, s34
    s_and_b32 s57, s35, 0xffff
    s_mov_b32 s58, 0x700
    s_mov_b32 s59, 0x20000
    s_lshl_b32 s60, s3, 3
    v_and_b32 v30, 31, v1
    v_mul_u32_u24 v30, 80, v30
    v_lshrrev_b32 v31, 5, v1
    v_lshl_add_u32 v28, v31, 2, v30
    v_add_u32 v28, s60, v28
    v_lshl_add_u32 v34, v31, 5, v30
    v_and_b32 v30, 1, v27
    v_mul_u32_u24 v30, 896, v30
    v_lshl_add_u32 v36, v26, 1, v30
    s_lshl_b32 s63, s55, 5
    s_cmp_lg_u32 s3, 7
    s_cbranch_scc1 L_f2a
    v_and_b32 v30, 1, v27
    v_mul_u32_u24 v35, 3584, v31
    v_lshl_add_u32 v35, v30, 14, v35
    v_and_b32 v30, 14, v26
    v_lshl_add_u32 v35, v30, 1, v35
    s_add_u32 s60, s63, 0xc4000
    v_and_b32 v32, 1, v26
    v_lshlrev_b32 v32, 4, v32
    v_xor_b32 v32, 16, v32
    s_waitcnt vmcnt(0)
    s_barrier
    s_mov_b32 s64, 0
L_poll_86:
    buffer_load_dword v144, v35, s[40:43], s60 offen offset:0 sc1
    buffer_load_dword v145, v35, s[40:43], s60 offen offset:896 sc1
    buffer_load_dword v146, v35, s[40:43], s60 offen offset:1792 sc1
    buffer_load_dword v147, v35, s[40:43], s60 offen offset:2688 sc1
    s_waitcnt vmcnt(0)
    v_max_u32 v30, v144, v145
    v_max3_u32 v30, v30, v146, v147
    v_cmp_eq_u32 vcc, -1, v30
    s_cbranch_vccz L_polld_87
    s_mov_b64 exec, vcc
    s_add_u32 s64, s64, 1
    s_cmp_lt_u32 s64, 120000
    s_cbranch_scc1 L_poll_86
L_polld_87:
    s_mov_b64 exec, -1
    s_barrier
    v_lshlrev_b32 v152, v32, v144
    v_and_b32 v152, 0xffff0000, v152
    v_lshlrev_b32 v153, v32, v145
    v_and_b32 v153, 0xffff0000, v153
    v_lshlrev_b32 v154, v32, v146
    v_and_b32 v154, 0xffff0000, v154
    v_lshlrev_b32 v155, v32, v147
    v_and_b32 v155, 0xffff0000, v155
    v_add_f32 v152, v152, v153
    v_add_f32 v154, v154, v155
    v_add_f32 v152, v152, v154
    ds_write_b32 v28, v152 offset:2816
    s_branch L_f2go
L_f2a:
    v_lshlrev_b32 v35, 4, v1
    s_lshl_b32 s60, s3, 10
    s_add_u32 s60, s60, 0xcc000
    s_waitcnt lgkmcnt(0)
    s_barrier
    s_barrier
    s_mov_b32 s64, 0
L_poll_88:
    buffer_load_dwordx4 v[144:147], v35, s[40:43], s60 offen sc1
    s_waitcnt vmcnt(0)
    v_max_u32 v30, v144, v145
    v_max3_u32 v30, v30, v146, v147
    v_cmp_eq_u32 vcc, -1, v30
    s_cbranch_vccz L_polld_89
    s_mov_b64 exec, vcc
    s_add_u32 s64, s64, 1
    s_cmp_lt_u32 s64, 120000
    s_cbranch_scc1 L_poll_88
L_polld_89:
    s_mov_b64 exec, -1
L_f2go:
    v_mfma_f32_16x16x32_bf16 v[112:115], v[144:147], v[80:83], 0
    v_mfma_f32_16x16x32_bf16 v[116:119], v[144:147], v[84:87], 0
    v_mfma_f32_16x16x32_bf16 v[120:123], v[144:147], v[88:91], 0
    v_mfma_f32_16x16x32_bf16 v[124:127], v[144:147], v[92:95], 0
    v_mfma_f32_16x16x32_bf16 v[128:131], v[144:147], v[96:99], 0
    v_mfma_f32_16x16x32_bf16 v[132:135], v[144:147], v[100:103], 0
    v_mfma_f32_16x16x32_bf16 v[136:139], v[144:147], v[104:107], 0
    v_mfma_f32_16x16x32_bf16 v[140:143], v[144:147], v[108:111], 0
    s_nop 1
    v_add_f32_dpp v148, v112, v118 quad_perm:[0,1,2,3] row_mask:0x1 bank_mask:0xf
    v_add_f32_dpp v149, v113, v119 quad_perm:[0,1,2,3] row_mask:0x1 bank_mask:0xf
    v_add_f32_dpp v148, v120, v126 quad_perm:[0,1,2,3] row_mask:0x2 bank_mask:0xf
    v_add_f32_dpp v149, v121, v127 quad_perm:[0,1,2,3] row_mask:0x2 bank_mask:0xf
    v_add_f32_dpp v148, v128, v134 quad_perm:[0,1,2,3] row_mask:0x4 bank_mask:0xf
    v_add_f32_dpp v149, v129, v135 quad_perm:[0,1,2,3] row_mask:0x4 bank_mask:0xf
    v_add_f32_dpp v148, v136, v142 quad_perm:[0,1,2,3] row_mask:0x8 bank_mask:0xf
    v_add_f32_dpp v149, v137, v143 quad_perm:[0,1,2,3] row_mask:0x8 bank_mask:0xf
    s_mov_b64 exec, s[92:93]
    s_nop 0
    v_permlane16_swap_b32 v148, v149
    v_add_f32 v148, v148, v149
    ds_write_b32 v28, v148 offset:2816
    s_mov_b64 exec, 1
    ds_add_rtn_u32 v33, v189, v33 offset:2332
    s_mov_b64 exec, -1
    ds_read_b128 v[152:155], v34 offset:2816
    ds_read_b128 v[156:159], v34 offset:2832
    s_mov_b32 vcc_lo, 0
    s_mov_b32 vcc_hi, -1
    s_waitcnt lgkmcnt(0)
    v_readfirstlane_b32 s60, v33
    v_pk_add_f32 v[152:153], v[152:153], v[154:155]
    v_add_f32 v158, v158, v159
    v_pk_add_f32 v[152:153], v[152:153], v[156:157]
    v_cndmask_b32 v159, v158, 0, vcc
    v_add_f32 v152, v152, v153
    v_add_f32 v152, v152, v159
    v_mov_b32 v153, v152
    s_cmp_eq_u32 s60, 7
    s_nop 0
    v_permlane32_swap_b32 v152, v153
    s_mov_b32 exec_lo, 0
    s_cselect_b32 exec_hi, -1, 0
    v_add_f32 v152, v152, v153
    v_cvt_pk_bf16_f32 v153, v152, v158
    v_lshlrev_b32 v152, 16, v153
    v_and_b32 v153, 0xffff0000, v153
    v_add_f32 v152, v152, v153
    v_cvt_pk_bf16_f32 v152, v152, v152
    buffer_store_short v152, v36, s[56:59], s63 offen
    s_cmp_lg_u32 s55, 0
    s_cbranch_scc1 L_noep
    v_mov_b32 v30, s53
    s_and_b32 exec_hi, exec_hi, 1
    global_store_dword v189, v30, s[38:39] offset:0
    global_store_dword v189, v189, s[36:37]
L_noep:
    s_mov_b64 exec, -1
L_exit:
L_end:
    s_endpgm
L_spin_25:
    s_mov_b32 s64, 0
L_slp_26:
    s_mov_b64 exec, 1
    ds_read_b32 v188, v3 offset:22528
    s_mov_b64 exec, -1
    s_waitcnt lgkmcnt(0)
    v_readfirstlane_b32 s68, v188
    s_cmp_lg_u32 s68, -1
    s_cbranch_scc1 L_rb_24
    s_add_u32 s64, s64, 1
    s_cmp_lt_u32 s64, 480000
    s_cbranch_scc1 L_slp_26
    s_mov_b32 s68, 0x40600003
    s_branch L_rb_24
L_spin_28:
    s_mov_b32 s64, 0
L_slp_29:
    s_mov_b64 exec, 1
    ds_read_b32 v188, v3 offset:22528
    s_mov_b64 exec, -1
    s_waitcnt lgkmcnt(0)
    v_readfirstlane_b32 s68, v188
    s_cmp_lg_u32 s68, -1
    s_cbranch_scc1 L_rb_27
    s_add_u32 s64, s64, 1
    s_cmp_lt_u32 s64, 480000
    s_cbranch_scc1 L_slp_29
    s_mov_b32 s68, 0x40600003
    s_branch L_rb_27
L_uslow_72:
    s_mov_b32 s64, 0
L_ulp_74:
    ds_read_b32 v184, v185
    s_waitcnt lgkmcnt(0)
    v_cmp_eq_u32 vcc, -1, v184
    s_cbranch_vccz L_uback_73
    s_add_u32 s64, s64, 1
    s_cmp_lt_u32 s64, 480000
    s_cbranch_scc1 L_ulp_74
    s_branch L_uback_73
L_resc_75:
    s_nop 1
    v_max_f32_dpp v30, v32, v32 row_ror:8 row_mask:0xf bank_mask:0xf
    s_nop 1
    v_max_f32_dpp v30, v30, v30 row_ror:4 row_mask:0xf bank_mask:0xf
    v_mov_b32 v31, v30
    s_nop 1
    v_permlane16_swap_b32 v30, v31
    s_nop 1
    v_max_f32 v30, v30, v31
    v_mov_b32 v31, v30
    s_nop 1
    v_permlane32_swap_b32 v30, v31
    s_nop 1
    v_max_f32 v30, v30, v31
    v_mul_f32 v31, s52, v30
    v_readfirstlane_b32 s51, v30
    v_sub_f32_e64 v37, -v25, v31
    v_exp_f32 v37, v37
    v_sub_f32 v25, 0, v31
    s_nop 7
    v_mul_f32 v16, v16, v37
    v_mul_f32 v17, v17, v37
    v_mul_f32 v18, v18, v37
    v_mul_f32 v19, v19, v37
    v_mul_f32 v20, v20, v37
    v_mul_f32 v21, v21, v37
    v_mul_f32 v22, v22, v37
    v_mul_f32 v23, v23, v37
    v_mul_f32 v24, v24, v37
    s_branch L_back_76
L_spin_78:
    s_mov_b32 s64, 0
L_slp_79:
    s_mov_b64 exec, 1
    ds_read_b32 v188, v3 offset:22528
    s_mov_b64 exec, -1
    s_waitcnt lgkmcnt(0)
    v_readfirstlane_b32 s68, v188
    s_cmp_lg_u32 s68, -1
    s_cbranch_scc1 L_rb_77
    s_add_u32 s64, s64, 1
    s_cmp_lt_u32 s64, 480000
    s_cbranch_scc1 L_slp_79
    s_mov_b32 s68, 0x40600003
    s_branch L_rb_77
.section .rodata,"a"
.p2align 6
.amdhsa_kernel sequential_preLN__mha_block_cached__geglu_ffn__decode_kernel
  .amdhsa_next_free_vgpr 256
  .amdhsa_next_free_sgpr 102
  .amdhsa_accum_offset 256
  .amdhsa_group_segment_fixed_size 0
  .amdhsa_kernarg_size 96
  .amdhsa_user_sgpr_count 2
  .amdhsa_user_sgpr_kernarg_segment_ptr 1
  .amdhsa_system_sgpr_workgroup_id_x 1
.end_amdhsa_kernel
```
